```python
import torch

def _softmax(x, axis=-1):
    return torch.softmax(x, dim=axis)
def _gelu(x):
    return torch.nn.functional.gelu(x, approximate="tanh")
def _silu(x):
    return torch.nn.functional.silu(x)
def _sigmoid(x):
    return torch.sigmoid(x)
def _layernorm(x, axis=-1, eps=1e-5):
    m = x.mean(dim=axis, keepdim=True)
    v = x.var(dim=axis, keepdim=True, unbiased=False)
    return (x - m) / torch.sqrt(v + eps)
def _scatter_add(tgt, idx, src, axis=0):
    return tgt.clone().index_add_(axis, idx, src)
def _segment_sum(src, seg, n):
    out = torch.zeros((n,) + src.shape[1:], dtype=src.dtype)
    return out.index_add_(0, seg, src)
def _pad(x, pw):
    flat = tuple(v for pair in reversed(pw) for v in pair)
    return torch.nn.functional.pad(x, flat)

kernel_name = 'standalone__gqa_block_cached__near_ridge'

def setup_inputs():

    _w = (lambda a: (lambda t: t.to(torch.bfloat16) if t.is_floating_point() else t)(torch.as_tensor(a)))
    B, Sq, D = 8, 144, 512
    Hq, Hkv, Sk, Dh = 32, 32, 1024, 128
    assert Hq % Hkv == 0, (Hq, Hkv)
    return {
        "x": _w((lambda *s: torch.randn(*s, dtype=torch.bfloat16) * 0.8)(B, Sq, D)),
        "k_cache": _w((lambda *s: torch.randn(*s, dtype=torch.bfloat16) * 0.8)(B, Hkv, Sk, Dh)),
        "v_cache": _w((lambda *s: torch.randn(*s, dtype=torch.bfloat16) * 0.05)(B, Hkv, Sk, Dh)),
        "wq": _w((lambda *s: torch.randn(*s, dtype=torch.bfloat16) * 0.8)(D, Hq * Dh) * (D ** -0.5)),
        "wo": _w((lambda *s: torch.randn(*s, dtype=torch.bfloat16) * 0.05)(Hq * Dh, D) * ((Hq * Dh) ** -0.5)),
    }

def reference(x, k_cache, v_cache, wq, wo):
    B, Sq, D = x.shape
    Hq, Dh = 32, 128
    Hkv = k_cache.shape[1]
    rep = Hq // Hkv
    q = (lambda x, *d: x.permute(*d))((x @ wq).reshape(B, Sq, Hq, Dh), 0, 2, 1, 3)
    k = (lambda x, n, axis: torch.repeat_interleave(x, n, dim=axis))(k_cache, rep, axis=1)
    v = (lambda x, n, axis: torch.repeat_interleave(x, n, dim=axis))(v_cache, rep, axis=1)
    scores = torch.einsum("bhqd,bhkd->bhqk", q, k) * (Dh ** -0.5)
    p = _softmax(scores, axis=-1)
    o = torch.einsum("bhqk,bhkd->bhqd", p, v)
    return (lambda x, *d: x.permute(*d))(o, 0, 2, 1, 3).reshape(B, Sq, Hq * Dh) @ wo
```

```asm
; @launch grid=(256,1,1) block=(512,1,1) lds=163840
.amdgcn_target "amdgcn-amd-amdhsa--gfx950"
.text

.globl standalone__gqa_block_cached__near_ridge_kernel
.p2align 8
.type standalone__gqa_block_cached__near_ridge_kernel,@function
standalone__gqa_block_cached__near_ridge_kernel:
  s_cmp_ge_u32 s2, 256
  s_cbranch_scc1 L_attn_done
  s_load_dwordx8 s[4:11], s[0:1], 0
  s_load_dwordx2 s[12:13], s[0:1], 56
  s_load_dwordx8 s[72:79], s[0:1], 32
  v_lshrrev_b32 v1, 6, v0
  v_and_b32 v0, 63, v0
  s_nop 0
  v_readfirstlane_b32 s36, v1
  v_and_b32 v1, 15, v0
  v_lshrrev_b32 v2, 4, v0
  s_and_b32 s3, s2, 7
  s_lshr_b32 s37, s2, 3
  s_and_b32 s38, s37, 3
  s_lshl_b32 s3, s3, 2
  s_add_u32 s38, s38, s3
  s_lshr_b32 s37, s37, 2
  s_mov_b32 s44, 0x3e0293ee
  s_cmp_eq_u32 s36, 6
  s_cselect_b64 s[48:49], -1, 0
  s_waitcnt lgkmcnt(0)
  s_mul_i32 s40, s37, 147456
  s_add_u32 s28, s4, s40
  s_addc_u32 s29, s5, 0
  s_mov_b32 s30, 147456
  s_mov_b32 s31, 0x00020000
  s_cmp_ge_u32 s36, 6
  s_cbranch_scc1 L_prod
  s_cmp_ge_u32 s36, 4
  s_cbranch_scc1 L_c1
  s_lshl_b32 s3, s36, 12
  s_add_u32 s3, s3, 16384
  v_lshrrev_b32 v24, 1, v1
  v_xor_b32 v25, v2, v24
  v_lshlrev_b32 v26, 7, v1
  v_add_u32 v26, s3, v26
  v_lshl_add_u32 v4, v25, 4, v26
  v_xor_b32 v25, 4, v25
  v_lshl_add_u32 v5, v25, 4, v26
  v_bfe_u32 v24, v0, 2, 2
  v_and_b32 v25, 3, v0
  v_and_b32 v26, 1, v2
  v_lshl_add_u32 v27, v2, 3, v24
  v_lshl_add_u32 v26, v26, 2, v24
  v_lshlrev_b32 v27, 8, v27
  v_lshrrev_b32 v3, 1, v25
  v_lshl_add_u32 v27, v3, 4, v27
  v_and_b32 v3, 1, v25
  v_lshl_add_u32 v27, v3, 3, v27
  v_xor_b32 v3, 0, v26
  v_lshl_add_u32 v14, v3, 5, v27
  v_xor_b32 v3, 1, v26
  v_lshl_add_u32 v15, v3, 5, v27
  v_xor_b32 v3, 2, v26
  v_lshl_add_u32 v16, v3, 5, v27
  v_xor_b32 v3, 3, v26
  v_lshl_add_u32 v17, v3, 5, v27
  v_xor_b32 v3, 4, v26
  v_lshl_add_u32 v18, v3, 5, v27
  v_xor_b32 v3, 5, v26
  v_lshl_add_u32 v19, v3, 5, v27
  v_xor_b32 v3, 6, v26
  v_lshl_add_u32 v20, v3, 5, v27
  v_xor_b32 v3, 7, v26
  v_lshl_add_u32 v21, v3, 5, v27
  v_mov_b32 v60, 0
  v_mov_b32 v61, 0
  v_mov_b32 v62, 0
  v_mov_b32 v63, 0
  v_mov_b32 v64, 0
  v_mov_b32 v65, 0
  v_mov_b32 v66, 0
  v_mov_b32 v67, 0
  v_mov_b32 v68, 0
  v_mov_b32 v69, 0
  v_mov_b32 v70, 0
  v_mov_b32 v71, 0
  v_mov_b32 v72, 0
  v_mov_b32 v73, 0
  v_mov_b32 v74, 0
  v_mov_b32 v75, 0
  v_mov_b32 v76, 0
  v_mov_b32 v77, 0
  v_mov_b32 v78, 0
  v_mov_b32 v79, 0
  v_mov_b32 v80, 0
  v_mov_b32 v81, 0
  v_mov_b32 v82, 0
  v_mov_b32 v83, 0
  v_mov_b32 v84, 0
  v_mov_b32 v85, 0
  v_mov_b32 v86, 0
  v_mov_b32 v87, 0
  v_mov_b32 v88, 0
  v_mov_b32 v89, 0
  v_mov_b32 v90, 0
  v_mov_b32 v91, 0
  v_mov_b32 v92, 0
  v_mov_b32 v93, 0
  v_mov_b32 v94, 0
  v_mov_b32 v95, 0
  v_mov_b32 v96, 0
  v_mov_b32 v97, 0
  v_mov_b32 v98, 0
  v_mov_b32 v99, 0
  v_mov_b32 v100, 0
  v_mov_b32 v101, 0
  v_mov_b32 v102, 0
  v_mov_b32 v103, 0
  v_mov_b32 v104, 0
  v_mov_b32 v105, 0
  v_mov_b32 v106, 0
  v_mov_b32 v107, 0
  v_mov_b32 v108, 0
  v_mov_b32 v109, 0
  v_mov_b32 v110, 0
  v_mov_b32 v111, 0
  v_mov_b32 v112, 0
  v_mov_b32 v113, 0
  v_mov_b32 v114, 0
  v_mov_b32 v115, 0
  v_mov_b32 v116, 0
  v_mov_b32 v117, 0
  v_mov_b32 v118, 0
  v_mov_b32 v119, 0
  v_mov_b32 v120, 0
  v_mov_b32 v121, 0
  v_mov_b32 v122, 0
  v_mov_b32 v123, 0
  s_mov_b32 s40, 0
L_qc2:
  s_barrier
  ds_read_b128 v[124:127], v4 offset:0
  ds_read_b128 v[128:131], v5 offset:0
  ds_read_b128 v[132:135], v4 offset:2048
  ds_read_b128 v[136:139], v5 offset:2048
  ds_read_b64_tr_b16 v[168:169], v14 offset:0
  ds_read_b64_tr_b16 v[170:171], v14 offset:1024
  ds_read_b64_tr_b16 v[172:173], v15 offset:0
  ds_read_b64_tr_b16 v[174:175], v15 offset:1024
  ds_read_b64_tr_b16 v[176:177], v16 offset:0
  ds_read_b64_tr_b16 v[178:179], v16 offset:1024
  ds_read_b64_tr_b16 v[180:181], v17 offset:0
  ds_read_b64_tr_b16 v[182:183], v17 offset:1024
  ds_read_b64_tr_b16 v[184:185], v18 offset:0
  ds_read_b64_tr_b16 v[186:187], v18 offset:1024
  ds_read_b64_tr_b16 v[188:189], v19 offset:0
  ds_read_b64_tr_b16 v[190:191], v19 offset:1024
  ds_read_b64_tr_b16 v[192:193], v20 offset:0
  ds_read_b64_tr_b16 v[194:195], v20 offset:1024
  ds_read_b64_tr_b16 v[196:197], v21 offset:0
  ds_read_b64_tr_b16 v[198:199], v21 offset:1024
  s_waitcnt lgkmcnt(12)
  v_mfma_f32_16x16x32_bf16 v[60:63], v[168:171], v[124:127], v[60:63]
  v_mfma_f32_16x16x32_bf16 v[92:95], v[168:171], v[132:135], v[92:95]
  ds_read_b64_tr_b16 v[168:169], v14 offset:8192
  ds_read_b64_tr_b16 v[170:171], v14 offset:9216
  v_mfma_f32_16x16x32_bf16 v[64:67], v[172:175], v[124:127], v[64:67]
  v_mfma_f32_16x16x32_bf16 v[96:99], v[172:175], v[132:135], v[96:99]
  ds_read_b64_tr_b16 v[172:173], v15 offset:8192
  ds_read_b64_tr_b16 v[174:175], v15 offset:9216
  s_waitcnt lgkmcnt(12)
  v_mfma_f32_16x16x32_bf16 v[68:71], v[176:179], v[124:127], v[68:71]
  v_mfma_f32_16x16x32_bf16 v[100:103], v[176:179], v[132:135], v[100:103]
  ds_read_b64_tr_b16 v[176:177], v16 offset:8192
  ds_read_b64_tr_b16 v[178:179], v16 offset:9216
  v_mfma_f32_16x16x32_bf16 v[72:75], v[180:183], v[124:127], v[72:75]
  v_mfma_f32_16x16x32_bf16 v[104:107], v[180:183], v[132:135], v[104:107]
  ds_read_b64_tr_b16 v[180:181], v17 offset:8192
  ds_read_b64_tr_b16 v[182:183], v17 offset:9216
  s_waitcnt lgkmcnt(12)
  v_mfma_f32_16x16x32_bf16 v[76:79], v[184:187], v[124:127], v[76:79]
  v_mfma_f32_16x16x32_bf16 v[108:111], v[184:187], v[132:135], v[108:111]
  ds_read_b64_tr_b16 v[184:185], v18 offset:8192
  ds_read_b64_tr_b16 v[186:187], v18 offset:9216
  v_mfma_f32_16x16x32_bf16 v[80:83], v[188:191], v[124:127], v[80:83]
  v_mfma_f32_16x16x32_bf16 v[112:115], v[188:191], v[132:135], v[112:115]
  ds_read_b64_tr_b16 v[188:189], v19 offset:8192
  ds_read_b64_tr_b16 v[190:191], v19 offset:9216
  s_waitcnt lgkmcnt(12)
  v_mfma_f32_16x16x32_bf16 v[84:87], v[192:195], v[124:127], v[84:87]
  v_mfma_f32_16x16x32_bf16 v[116:119], v[192:195], v[132:135], v[116:119]
  ds_read_b64_tr_b16 v[192:193], v20 offset:8192
  ds_read_b64_tr_b16 v[194:195], v20 offset:9216
  v_mfma_f32_16x16x32_bf16 v[88:91], v[196:199], v[124:127], v[88:91]
  v_mfma_f32_16x16x32_bf16 v[120:123], v[196:199], v[132:135], v[120:123]
  ds_read_b64_tr_b16 v[196:197], v21 offset:8192
  ds_read_b64_tr_b16 v[198:199], v21 offset:9216
  s_waitcnt lgkmcnt(12)
  v_mfma_f32_16x16x32_bf16 v[60:63], v[168:171], v[128:131], v[60:63]
  v_mfma_f32_16x16x32_bf16 v[92:95], v[168:171], v[136:139], v[92:95]
  v_mfma_f32_16x16x32_bf16 v[64:67], v[172:175], v[128:131], v[64:67]
  v_mfma_f32_16x16x32_bf16 v[96:99], v[172:175], v[136:139], v[96:99]
  s_waitcnt lgkmcnt(8)
  v_mfma_f32_16x16x32_bf16 v[68:71], v[176:179], v[128:131], v[68:71]
  v_mfma_f32_16x16x32_bf16 v[100:103], v[176:179], v[136:139], v[100:103]
  v_mfma_f32_16x16x32_bf16 v[72:75], v[180:183], v[128:131], v[72:75]
  v_mfma_f32_16x16x32_bf16 v[104:107], v[180:183], v[136:139], v[104:107]
  s_waitcnt lgkmcnt(4)
  v_mfma_f32_16x16x32_bf16 v[76:79], v[184:187], v[128:131], v[76:79]
  v_mfma_f32_16x16x32_bf16 v[108:111], v[184:187], v[136:139], v[108:111]
  v_mfma_f32_16x16x32_bf16 v[80:83], v[188:191], v[128:131], v[80:83]
  v_mfma_f32_16x16x32_bf16 v[112:115], v[188:191], v[136:139], v[112:115]
  s_waitcnt lgkmcnt(0)
  v_mfma_f32_16x16x32_bf16 v[84:87], v[192:195], v[128:131], v[84:87]
  v_mfma_f32_16x16x32_bf16 v[116:119], v[192:195], v[136:139], v[116:119]
  v_mfma_f32_16x16x32_bf16 v[88:91], v[196:199], v[128:131], v[88:91]
  v_mfma_f32_16x16x32_bf16 v[120:123], v[196:199], v[136:139], v[120:123]
  s_add_u32 s40, s40, 1
  s_cmp_eq_u32 s40, 4
  s_mov_b32 s39, 0x8000
  s_cselect_b32 s3, 0xfffe8000, s39
  v_add_u32 v4, s3, v4
  v_add_u32 v5, s3, v5
  v_add_u32 v14, s3, v14
  v_add_u32 v15, s3, v15
  v_add_u32 v16, s3, v16
  v_add_u32 v17, s3, v17
  v_add_u32 v18, s3, v18
  v_add_u32 v19, s3, v19
  v_add_u32 v20, s3, v20
  v_add_u32 v21, s3, v21
  s_cmp_lt_u32 s40, 8
  s_cbranch_scc1 L_qc2
  v_mul_u32_u24 v3, 1024, v2
  v_add_u32 v3, 0, v3
  s_mov_b32 s3, 131072
  v_sub_u32 v14, v14, v3
  v_sub_u32 v15, v15, v3
  v_sub_u32 v16, v16, v3
  v_sub_u32 v17, v17, v3
  v_sub_u32 v18, v18, v3
  v_sub_u32 v19, v19, v3
  v_sub_u32 v20, v20, v3
  v_sub_u32 v21, v21, v3
  v_and_b32 v26, 1, v2
  v_lshrrev_b32 v27, 1, v2
  v_lshl_add_u32 v26, v26, 1, v27
  v_xor_b32 v26, v26, v1
  v_xor_b32 v3, 0, v26
  v_lshlrev_b32 v3, 4, v3
  v_lshl_add_u32 v10, v1, 8, v3
  v_add_u32 v10, s3, v10
  v_xor_b32 v3, 4, v26
  v_lshlrev_b32 v3, 4, v3
  v_lshl_add_u32 v11, v1, 8, v3
  v_add_u32 v11, s3, v11
  v_xor_b32 v3, 8, v26
  v_lshlrev_b32 v3, 4, v3
  v_lshl_add_u32 v12, v1, 8, v3
  v_add_u32 v12, s3, v12
  v_xor_b32 v3, 12, v26
  v_lshlrev_b32 v3, 4, v3
  v_lshl_add_u32 v13, v1, 8, v3
  v_add_u32 v13, s3, v13
  s_barrier
  ds_read_b128 v[168:171], v10 offset:0
  ds_read_b128 v[172:175], v11 offset:0
  ds_read_b128 v[176:179], v12 offset:0
  ds_read_b128 v[180:183], v13 offset:0
  ds_read_b128 v[184:187], v10 offset:4096
  ds_read_b128 v[188:191], v11 offset:4096
  ds_read_b128 v[192:195], v12 offset:4096
  ds_read_b128 v[196:199], v13 offset:4096
  ds_read_b128 v[200:203], v10 offset:8192
  ds_read_b128 v[204:207], v11 offset:8192
  ds_read_b128 v[208:211], v12 offset:8192
  ds_read_b128 v[212:215], v13 offset:8192
  ds_read_b128 v[216:219], v10 offset:12288
  ds_read_b128 v[220:223], v11 offset:12288
  ds_read_b128 v[224:227], v12 offset:12288
  ds_read_b128 v[228:231], v13 offset:12288
  v_mul_f32 v60, s44, v60
  v_mul_f32 v61, s44, v61
  v_mul_f32 v62, s44, v62
  v_mul_f32 v63, s44, v63
  v_mul_f32 v64, s44, v64
  v_mul_f32 v65, s44, v65
  v_mul_f32 v66, s44, v66
  v_mul_f32 v67, s44, v67
  v_mul_f32 v68, s44, v68
  v_mul_f32 v69, s44, v69
  v_mul_f32 v70, s44, v70
  v_mul_f32 v71, s44, v71
  v_mul_f32 v72, s44, v72
  v_mul_f32 v73, s44, v73
  v_mul_f32 v74, s44, v74
  v_mul_f32 v75, s44, v75
  v_mul_f32 v76, s44, v76
  v_mul_f32 v77, s44, v77
  v_mul_f32 v78, s44, v78
  v_mul_f32 v79, s44, v79
  v_mul_f32 v80, s44, v80
  v_mul_f32 v81, s44, v81
  v_mul_f32 v82, s44, v82
  v_mul_f32 v83, s44, v83
  v_mul_f32 v84, s44, v84
  v_mul_f32 v85, s44, v85
  v_mul_f32 v86, s44, v86
  v_mul_f32 v87, s44, v87
  v_mul_f32 v88, s44, v88
  v_mul_f32 v89, s44, v89
  v_mul_f32 v90, s44, v90
  v_mul_f32 v91, s44, v91
  v_cvt_pk_bf16_f32 v28, v60, v61
  v_cvt_pk_bf16_f32 v29, v62, v63
  v_cvt_pk_bf16_f32 v30, v64, v65
  v_cvt_pk_bf16_f32 v31, v66, v67
  v_cvt_pk_bf16_f32 v32, v68, v69
  v_cvt_pk_bf16_f32 v33, v70, v71
  v_cvt_pk_bf16_f32 v34, v72, v73
  v_cvt_pk_bf16_f32 v35, v74, v75
  v_cvt_pk_bf16_f32 v36, v76, v77
  v_cvt_pk_bf16_f32 v37, v78, v79
  v_cvt_pk_bf16_f32 v38, v80, v81
  v_cvt_pk_bf16_f32 v39, v82, v83
  v_cvt_pk_bf16_f32 v40, v84, v85
  v_cvt_pk_bf16_f32 v41, v86, v87
  v_cvt_pk_bf16_f32 v42, v88, v89
  v_cvt_pk_bf16_f32 v43, v90, v91
  v_mul_f32 v92, s44, v92
  v_mul_f32 v93, s44, v93
  v_mul_f32 v94, s44, v94
  v_mul_f32 v95, s44, v95
  v_mul_f32 v96, s44, v96
  v_mul_f32 v97, s44, v97
  v_mul_f32 v98, s44, v98
  v_mul_f32 v99, s44, v99
  v_mul_f32 v100, s44, v100
  v_mul_f32 v101, s44, v101
  v_mul_f32 v102, s44, v102
  v_mul_f32 v103, s44, v103
  v_mul_f32 v104, s44, v104
  v_mul_f32 v105, s44, v105
  v_mul_f32 v106, s44, v106
  v_mul_f32 v107, s44, v107
  v_mul_f32 v108, s44, v108
  v_mul_f32 v109, s44, v109
  v_mul_f32 v110, s44, v110
  v_mul_f32 v111, s44, v111
  v_mul_f32 v112, s44, v112
  v_mul_f32 v113, s44, v113
  v_mul_f32 v114, s44, v114
  v_mul_f32 v115, s44, v115
  v_mul_f32 v116, s44, v116
  v_mul_f32 v117, s44, v117
  v_mul_f32 v118, s44, v118
  v_mul_f32 v119, s44, v119
  v_mul_f32 v120, s44, v120
  v_mul_f32 v121, s44, v121
  v_mul_f32 v122, s44, v122
  v_mul_f32 v123, s44, v123
  v_cvt_pk_bf16_f32 v44, v92, v93
  v_cvt_pk_bf16_f32 v45, v94, v95
  v_cvt_pk_bf16_f32 v46, v96, v97
  v_cvt_pk_bf16_f32 v47, v98, v99
  v_cvt_pk_bf16_f32 v48, v100, v101
  v_cvt_pk_bf16_f32 v49, v102, v103
  v_cvt_pk_bf16_f32 v50, v104, v105
  v_cvt_pk_bf16_f32 v51, v106, v107
  v_cvt_pk_bf16_f32 v52, v108, v109
  v_cvt_pk_bf16_f32 v53, v110, v111
  v_cvt_pk_bf16_f32 v54, v112, v113
  v_cvt_pk_bf16_f32 v55, v114, v115
  v_cvt_pk_bf16_f32 v56, v116, v117
  v_cvt_pk_bf16_f32 v57, v118, v119
  v_cvt_pk_bf16_f32 v58, v120, v121
  v_cvt_pk_bf16_f32 v59, v122, v123
  v_mov_b32 v60, 0
  v_mov_b32 v61, 0
  v_mov_b32 v62, 0
  v_mov_b32 v63, 0
  v_mov_b32 v64, 0
  v_mov_b32 v65, 0
  v_mov_b32 v66, 0
  v_mov_b32 v67, 0
  v_mov_b32 v68, 0
  v_mov_b32 v69, 0
  v_mov_b32 v70, 0
  v_mov_b32 v71, 0
  v_mov_b32 v72, 0
  v_mov_b32 v73, 0
  v_mov_b32 v74, 0
  v_mov_b32 v75, 0
  v_mov_b32 v76, 0
  v_mov_b32 v77, 0
  v_mov_b32 v78, 0
  v_mov_b32 v79, 0
  v_mov_b32 v80, 0
  v_mov_b32 v81, 0
  v_mov_b32 v82, 0
  v_mov_b32 v83, 0
  v_mov_b32 v84, 0
  v_mov_b32 v85, 0
  v_mov_b32 v86, 0
  v_mov_b32 v87, 0
  v_mov_b32 v88, 0
  v_mov_b32 v89, 0
  v_mov_b32 v90, 0
  v_mov_b32 v91, 0
  v_mov_b32 v92, 0
  v_mov_b32 v93, 0
  v_mov_b32 v94, 0
  v_mov_b32 v95, 0
  v_mov_b32 v96, 0
  v_mov_b32 v97, 0
  v_mov_b32 v98, 0
  v_mov_b32 v99, 0
  v_mov_b32 v100, 0
  v_mov_b32 v101, 0
  v_mov_b32 v102, 0
  v_mov_b32 v103, 0
  v_mov_b32 v104, 0
  v_mov_b32 v105, 0
  v_mov_b32 v106, 0
  v_mov_b32 v107, 0
  v_mov_b32 v108, 0
  v_mov_b32 v109, 0
  v_mov_b32 v110, 0
  v_mov_b32 v111, 0
  v_mov_b32 v112, 0
  v_mov_b32 v113, 0
  v_mov_b32 v114, 0
  v_mov_b32 v115, 0
  v_mov_b32 v116, 0
  v_mov_b32 v117, 0
  v_mov_b32 v118, 0
  v_mov_b32 v119, 0
  v_mov_b32 v120, 0
  v_mov_b32 v121, 0
  v_mov_b32 v122, 0
  v_mov_b32 v123, 0
  v_permlane16_swap_b32 v28, v30
  v_permlane16_swap_b32 v29, v31
  v_permlane16_swap_b32 v32, v34
  v_permlane16_swap_b32 v33, v35
  v_permlane16_swap_b32 v36, v38
  v_permlane16_swap_b32 v37, v39
  v_permlane16_swap_b32 v40, v42
  v_permlane16_swap_b32 v41, v43
  v_permlane16_swap_b32 v44, v46
  v_permlane16_swap_b32 v45, v47
  v_permlane16_swap_b32 v48, v50
  v_permlane16_swap_b32 v49, v51
  v_permlane16_swap_b32 v52, v54
  v_permlane16_swap_b32 v53, v55
  v_permlane16_swap_b32 v56, v58
  v_permlane16_swap_b32 v57, v59
  v_mov_b32 v156, 0x3f803f80
  v_mov_b32 v157, 0x3f803f80
  v_mov_b32 v158, 0x3f803f80
  v_mov_b32 v159, 0x3f803f80
  v_mov_b32 v160, 0
  v_mov_b32 v161, 0
  v_mov_b32 v162, 0
  v_mov_b32 v163, 0
  v_mov_b32 v232, 0
  v_mov_b32 v233, 0
  v_mov_b32 v234, 0
  v_mov_b32 v235, 0
  s_mov_b32 s60, 0xff800000
  s_mov_b32 s61, 0xff800000
  v_mov_b32 v164, 0
  v_mov_b32 v165, 0
  v_mov_b32 v166, 0
  v_mov_b32 v167, 0
  v_mov_b32 v236, 0
  v_mov_b32 v237, 0
  v_mov_b32 v238, 0
  v_mov_b32 v239, 0
  s_mov_b32 s62, 0xff800000
  s_mov_b32 s63, 0xff800000
  s_mov_b32 s40, 0
  s_mov_b32 s41, 131072
L_loopc2:
  s_add_u32 s42, s41, 32768
  s_cmp_ge_u32 s42, 163840
  s_cselect_b32 s42, 0, s42
  s_sub_u32 s3, s42, s41
  s_waitcnt lgkmcnt(12)
  v_mfma_f32_16x16x32_bf16 v[124:127], v[168:171], v[28:31], v[232:235]
  v_mfma_f32_16x16x32_bf16 v[124:127], v[172:175], v[32:35], v[124:127]
  v_mfma_f32_16x16x32_bf16 v[124:127], v[176:179], v[36:39], v[124:127]
  v_mfma_f32_16x16x32_bf16 v[124:127], v[180:183], v[40:43], v[124:127]
  s_waitcnt lgkmcnt(8)
  v_mfma_f32_16x16x32_bf16 v[128:131], v[184:187], v[28:31], v[232:235]
  v_mfma_f32_16x16x32_bf16 v[128:131], v[188:191], v[32:35], v[128:131]
  v_mfma_f32_16x16x32_bf16 v[128:131], v[192:195], v[36:39], v[128:131]
  v_mfma_f32_16x16x32_bf16 v[128:131], v[196:199], v[40:43], v[128:131]
  s_waitcnt lgkmcnt(4)
  v_mfma_f32_16x16x32_bf16 v[132:135], v[200:203], v[28:31], v[232:235]
  v_mfma_f32_16x16x32_bf16 v[132:135], v[204:207], v[32:35], v[132:135]
  v_mfma_f32_16x16x32_bf16 v[132:135], v[208:211], v[36:39], v[132:135]
  v_mfma_f32_16x16x32_bf16 v[132:135], v[212:215], v[40:43], v[132:135]
  s_waitcnt lgkmcnt(0)
  v_mfma_f32_16x16x32_bf16 v[136:139], v[216:219], v[28:31], v[232:235]
  v_mfma_f32_16x16x32_bf16 v[136:139], v[220:223], v[32:35], v[136:139]
  v_mfma_f32_16x16x32_bf16 v[136:139], v[224:227], v[36:39], v[136:139]
  v_mfma_f32_16x16x32_bf16 v[136:139], v[228:231], v[40:43], v[136:139]
  v_mfma_f32_16x16x32_bf16 v[140:143], v[168:171], v[44:47], v[236:239]
  ds_read_b64_tr_b16 v[168:169], v14 offset:16384
  ds_read_b64_tr_b16 v[170:171], v14 offset:20480
  v_mfma_f32_16x16x32_bf16 v[140:143], v[172:175], v[48:51], v[140:143]
  ds_read_b64_tr_b16 v[172:173], v15 offset:16384
  ds_read_b64_tr_b16 v[174:175], v15 offset:20480
  v_add_u32 v10, s3, v10
  v_add_u32 v11, s3, v11
  v_add_u32 v12, s3, v12
  v_mfma_f32_16x16x32_bf16 v[140:143], v[176:179], v[52:55], v[140:143]
  ds_read_b64_tr_b16 v[176:177], v16 offset:16384
  ds_read_b64_tr_b16 v[178:179], v16 offset:20480
  v_add_u32 v13, s3, v13
  v_max3_f32 v24, v124, v125, v126
  v_max3_f32 v25, v127, v128, v129
  v_mfma_f32_16x16x32_bf16 v[140:143], v[180:183], v[56:59], v[140:143]
  ds_read_b64_tr_b16 v[180:181], v17 offset:16384
  ds_read_b64_tr_b16 v[182:183], v17 offset:20480
  v_max3_f32 v24, v24, v130, v131
  v_max3_f32 v25, v25, v132, v133
  v_max3_f32 v24, v24, v134, v135
  v_mfma_f32_16x16x32_bf16 v[144:147], v[184:187], v[44:47], v[236:239]
  ds_read_b64_tr_b16 v[184:185], v18 offset:16384
  ds_read_b64_tr_b16 v[186:187], v18 offset:20480
  v_max3_f32 v25, v25, v136, v137
  v_max3_f32 v24, v24, v138, v139
  v_max_f32 v24, v24, v25
  v_mfma_f32_16x16x32_bf16 v[144:147], v[188:191], v[48:51], v[144:147]
  ds_read_b64_tr_b16 v[188:189], v19 offset:16384
  ds_read_b64_tr_b16 v[190:191], v19 offset:20480
  v_cmp_lt_f32 vcc, s60, v24
  s_cbranch_vccnz L_slowc2a
L_backc2a:
  v_exp_f32 v124, v124
  v_exp_f32 v125, v125
  v_mfma_f32_16x16x32_bf16 v[144:147], v[192:195], v[52:55], v[144:147]
  ds_read_b64_tr_b16 v[192:193], v20 offset:16384
  ds_read_b64_tr_b16 v[194:195], v20 offset:20480
  v_exp_f32 v126, v126
  v_exp_f32 v127, v127
  v_exp_f32 v128, v128
  v_mfma_f32_16x16x32_bf16 v[144:147], v[196:199], v[56:59], v[144:147]
  ds_read_b64_tr_b16 v[196:197], v21 offset:16384
  ds_read_b64_tr_b16 v[198:199], v21 offset:20480
  v_exp_f32 v129, v129
  v_exp_f32 v130, v130
  v_exp_f32 v131, v131
  v_mfma_f32_16x16x32_bf16 v[148:151], v[200:203], v[44:47], v[236:239]
  ds_read_b64_tr_b16 v[200:201], v14 offset:24576
  ds_read_b64_tr_b16 v[202:203], v14 offset:28672
  v_exp_f32 v132, v132
  v_exp_f32 v133, v133
  v_exp_f32 v134, v134
  v_mfma_f32_16x16x32_bf16 v[148:151], v[204:207], v[48:51], v[148:151]
  ds_read_b64_tr_b16 v[204:205], v15 offset:24576
  ds_read_b64_tr_b16 v[206:207], v15 offset:28672
  v_exp_f32 v135, v135
  v_exp_f32 v136, v136
  v_exp_f32 v137, v137
  v_mfma_f32_16x16x32_bf16 v[148:151], v[208:211], v[52:55], v[148:151]
  ds_read_b64_tr_b16 v[208:209], v16 offset:24576
  ds_read_b64_tr_b16 v[210:211], v16 offset:28672
  v_exp_f32 v138, v138
  v_exp_f32 v139, v139
  s_nop 0
  v_mfma_f32_16x16x32_bf16 v[148:151], v[212:215], v[56:59], v[148:151]
  ds_read_b64_tr_b16 v[212:213], v17 offset:24576
  ds_read_b64_tr_b16 v[214:215], v17 offset:28672
  v_cvt_pk_bf16_f32 v124, v124, v125
  v_cvt_pk_bf16_f32 v125, v126, v127
  v_cvt_pk_bf16_f32 v126, v128, v129
  v_mfma_f32_16x16x32_bf16 v[152:155], v[216:219], v[44:47], v[236:239]
  ds_read_b64_tr_b16 v[216:217], v18 offset:24576
  ds_read_b64_tr_b16 v[218:219], v18 offset:28672
  v_cvt_pk_bf16_f32 v127, v130, v131
  v_cvt_pk_bf16_f32 v128, v132, v133
  v_cvt_pk_bf16_f32 v129, v134, v135
  v_mfma_f32_16x16x32_bf16 v[152:155], v[220:223], v[48:51], v[152:155]
  ds_read_b64_tr_b16 v[220:221], v19 offset:24576
  ds_read_b64_tr_b16 v[222:223], v19 offset:28672
  v_cvt_pk_bf16_f32 v130, v136, v137
  v_cvt_pk_bf16_f32 v131, v138, v139
  v_mfma_f32_16x16x32_bf16 v[152:155], v[224:227], v[52:55], v[152:155]
  ds_read_b64_tr_b16 v[224:225], v20 offset:24576
  ds_read_b64_tr_b16 v[226:227], v20 offset:28672
  v_mfma_f32_16x16x32_bf16 v[152:155], v[228:231], v[56:59], v[152:155]
  ds_read_b64_tr_b16 v[228:229], v21 offset:24576
  ds_read_b64_tr_b16 v[230:231], v21 offset:28672
  s_nop 1
  v_mfma_f32_16x16x32_bf16 v[160:163], v[156:159], v[124:127], v[160:163]
  s_waitcnt lgkmcnt(8)
  v_mfma_f32_16x16x32_bf16 v[60:63], v[168:171], v[124:127], v[60:63]
  v_mfma_f32_16x16x32_bf16 v[64:67], v[172:175], v[124:127], v[64:67]
  v_add_u32 v14, s3, v14
  v_add_u32 v15, s3, v15
  v_add_u32 v16, s3, v16
  v_mfma_f32_16x16x32_bf16 v[68:71], v[176:179], v[124:127], v[68:71]
  v_add_u32 v17, s3, v17
  v_add_u32 v18, s3, v18
  v_add_u32 v19, s3, v19
  v_mfma_f32_16x16x32_bf16 v[72:75], v[180:183], v[124:127], v[72:75]
  v_add_u32 v20, s3, v20
  v_add_u32 v21, s3, v21
  v_max3_f32 v6, v140, v141, v142
  v_mfma_f32_16x16x32_bf16 v[76:79], v[184:187], v[124:127], v[76:79]
  v_max3_f32 v7, v143, v144, v145
  v_max3_f32 v6, v6, v146, v147
  v_max3_f32 v7, v7, v148, v149
  v_mfma_f32_16x16x32_bf16 v[80:83], v[188:191], v[124:127], v[80:83]
  v_max3_f32 v6, v6, v150, v151
  v_max3_f32 v7, v7, v152, v153
  v_max3_f32 v6, v6, v154, v155
  v_mfma_f32_16x16x32_bf16 v[84:87], v[192:195], v[124:127], v[84:87]
  v_max_f32 v6, v6, v7
  v_cmp_lt_f32 vcc, s62, v6
  s_cbranch_vccnz L_slowc2b
L_backc2b:
  v_exp_f32 v140, v140
  v_mfma_f32_16x16x32_bf16 v[88:91], v[196:199], v[124:127], v[88:91]
  v_exp_f32 v141, v141
  v_exp_f32 v142, v142
  v_exp_f32 v143, v143
  v_mfma_f32_16x16x32_bf16 v[160:163], v[156:159], v[128:131], v[160:163]
  v_mfma_f32_16x16x32_bf16 v[60:63], v[200:203], v[128:131], v[60:63]
  v_exp_f32 v144, v144
  v_exp_f32 v145, v145
  v_exp_f32 v146, v146
  v_mfma_f32_16x16x32_bf16 v[64:67], v[204:207], v[128:131], v[64:67]
  v_exp_f32 v147, v147
  v_exp_f32 v148, v148
  v_exp_f32 v149, v149
  v_mfma_f32_16x16x32_bf16 v[68:71], v[208:211], v[128:131], v[68:71]
  v_exp_f32 v150, v150
  v_exp_f32 v151, v151
  v_exp_f32 v152, v152
  v_mfma_f32_16x16x32_bf16 v[72:75], v[212:215], v[128:131], v[72:75]
  v_exp_f32 v153, v153
  v_exp_f32 v154, v154
  v_exp_f32 v155, v155
  s_waitcnt lgkmcnt(0)
  v_mfma_f32_16x16x32_bf16 v[76:79], v[216:219], v[128:131], v[76:79]
  s_nop 0
  v_cvt_pk_bf16_f32 v140, v140, v141
  v_cvt_pk_bf16_f32 v141, v142, v143
  v_mfma_f32_16x16x32_bf16 v[80:83], v[220:223], v[128:131], v[80:83]
  v_cvt_pk_bf16_f32 v142, v144, v145
  v_cvt_pk_bf16_f32 v143, v146, v147
  v_cvt_pk_bf16_f32 v144, v148, v149
  v_mfma_f32_16x16x32_bf16 v[84:87], v[224:227], v[128:131], v[84:87]
  v_cvt_pk_bf16_f32 v145, v150, v151
  v_cvt_pk_bf16_f32 v146, v152, v153
  v_cvt_pk_bf16_f32 v147, v154, v155
  v_mfma_f32_16x16x32_bf16 v[88:91], v[228:231], v[128:131], v[88:91]
  s_barrier
  v_mfma_f32_16x16x32_bf16 v[164:167], v[156:159], v[140:143], v[164:167]
  v_mfma_f32_16x16x32_bf16 v[92:95], v[168:171], v[140:143], v[92:95]
  ds_read_b128 v[168:171], v10 offset:0
  v_mfma_f32_16x16x32_bf16 v[96:99], v[172:175], v[140:143], v[96:99]
  ds_read_b128 v[172:175], v11 offset:0
  v_mfma_f32_16x16x32_bf16 v[100:103], v[176:179], v[140:143], v[100:103]
  ds_read_b128 v[176:179], v12 offset:0
  v_mfma_f32_16x16x32_bf16 v[104:107], v[180:183], v[140:143], v[104:107]
  ds_read_b128 v[180:183], v13 offset:0
  v_mfma_f32_16x16x32_bf16 v[108:111], v[184:187], v[140:143], v[108:111]
  ds_read_b128 v[184:187], v10 offset:4096
  v_mfma_f32_16x16x32_bf16 v[112:115], v[188:191], v[140:143], v[112:115]
  ds_read_b128 v[188:191], v11 offset:4096
  v_mfma_f32_16x16x32_bf16 v[116:119], v[192:195], v[140:143], v[116:119]
  ds_read_b128 v[192:195], v12 offset:4096
  v_mfma_f32_16x16x32_bf16 v[120:123], v[196:199], v[140:143], v[120:123]
  ds_read_b128 v[196:199], v13 offset:4096
  v_mfma_f32_16x16x32_bf16 v[164:167], v[156:159], v[144:147], v[164:167]
  v_mfma_f32_16x16x32_bf16 v[92:95], v[200:203], v[144:147], v[92:95]
  ds_read_b128 v[200:203], v10 offset:8192
  v_mfma_f32_16x16x32_bf16 v[96:99], v[204:207], v[144:147], v[96:99]
  ds_read_b128 v[204:207], v11 offset:8192
  v_mfma_f32_16x16x32_bf16 v[100:103], v[208:211], v[144:147], v[100:103]
  ds_read_b128 v[208:211], v12 offset:8192
  v_mfma_f32_16x16x32_bf16 v[104:107], v[212:215], v[144:147], v[104:107]
  ds_read_b128 v[212:215], v13 offset:8192
  v_mfma_f32_16x16x32_bf16 v[108:111], v[216:219], v[144:147], v[108:111]
  ds_read_b128 v[216:219], v10 offset:12288
  v_mfma_f32_16x16x32_bf16 v[112:115], v[220:223], v[144:147], v[112:115]
  ds_read_b128 v[220:223], v11 offset:12288
  v_mfma_f32_16x16x32_bf16 v[116:119], v[224:227], v[144:147], v[116:119]
  ds_read_b128 v[224:227], v12 offset:12288
  v_mfma_f32_16x16x32_bf16 v[120:123], v[228:231], v[144:147], v[120:123]
  ds_read_b128 v[228:231], v13 offset:12288
  s_mov_b32 s41, s42
  s_add_u32 s40, s40, 1
  s_cmp_lt_u32 s40, 16
  s_cbranch_scc1 L_loopc2
  v_lshlrev_b32 v4, 4, v0
  v_add_u32 v5, 4096, v4
  s_barrier
  s_lshl_b32 s45, s36, 1
  s_mul_i32 s40, s37, 9
  s_add_u32 s40, s40, s45
  s_lshl_b32 s41, s40, 7
  s_lshl_b32 s39, s38, 2
  s_add_u32 s41, s41, s39
  s_lshl_b32 s41, s41, 10
  s_add_u32 s32, s12, s41
  s_addc_u32 s33, s13, 0
  s_mov_b32 s34, 135168
  s_mov_b32 s35, 0x00020000
  s_mov_b32 s46, 8192
  s_mov_b32 s47, 131072
  s_mov_b32 s48, 139264
  v_rcp_f32 v25, v160
  v_rcp_f32 v26, v164
  s_nop 0
  v_mul_f32 v60, v60, v25
  v_mul_f32 v61, v61, v25
  v_mul_f32 v62, v62, v25
  v_mul_f32 v63, v63, v25
  v_mul_f32 v64, v64, v25
  v_mul_f32 v65, v65, v25
  v_mul_f32 v66, v66, v25
  v_mul_f32 v67, v67, v25
  v_mul_f32 v68, v68, v25
  v_mul_f32 v69, v69, v25
  v_mul_f32 v70, v70, v25
  v_mul_f32 v71, v71, v25
  v_mul_f32 v72, v72, v25
  v_mul_f32 v73, v73, v25
  v_mul_f32 v74, v74, v25
  v_mul_f32 v75, v75, v25
  v_mul_f32 v76, v76, v25
  v_mul_f32 v77, v77, v25
  v_mul_f32 v78, v78, v25
  v_mul_f32 v79, v79, v25
  v_mul_f32 v80, v80, v25
  v_mul_f32 v81, v81, v25
  v_mul_f32 v82, v82, v25
  v_mul_f32 v83, v83, v25
  v_mul_f32 v84, v84, v25
  v_mul_f32 v85, v85, v25
  v_mul_f32 v86, v86, v25
  v_mul_f32 v87, v87, v25
  v_mul_f32 v88, v88, v25
  v_mul_f32 v89, v89, v25
  v_mul_f32 v90, v90, v25
  v_mul_f32 v91, v91, v25
  v_cvt_pk_bf16_f32 v28, v60, v61
  v_cvt_pk_bf16_f32 v29, v62, v63
  v_cvt_pk_bf16_f32 v30, v64, v65
  v_cvt_pk_bf16_f32 v31, v66, v67
  v_cvt_pk_bf16_f32 v32, v68, v69
  v_cvt_pk_bf16_f32 v33, v70, v71
  v_cvt_pk_bf16_f32 v34, v72, v73
  v_cvt_pk_bf16_f32 v35, v74, v75
  v_cvt_pk_bf16_f32 v36, v76, v77
  v_cvt_pk_bf16_f32 v37, v78, v79
  v_cvt_pk_bf16_f32 v38, v80, v81
  v_cvt_pk_bf16_f32 v39, v82, v83
  v_cvt_pk_bf16_f32 v40, v84, v85
  v_cvt_pk_bf16_f32 v41, v86, v87
  v_cvt_pk_bf16_f32 v42, v88, v89
  v_cvt_pk_bf16_f32 v43, v90, v91
  s_nop 1
  v_permlane16_swap_b32 v28, v30
  v_permlane16_swap_b32 v29, v31
  v_permlane16_swap_b32 v32, v34
  v_permlane16_swap_b32 v33, v35
  v_permlane16_swap_b32 v36, v38
  v_permlane16_swap_b32 v37, v39
  v_permlane16_swap_b32 v40, v42
  v_permlane16_swap_b32 v41, v43
  buffer_store_dwordx4 v[28:31], v4, s[32:35], 0 offen offset:0 sc1
  buffer_store_dwordx4 v[32:35], v4, s[32:35], 0 offen offset:1024 sc1
  buffer_store_dwordx4 v[36:39], v4, s[32:35], 0 offen offset:2048 sc1
  buffer_store_dwordx4 v[40:43], v4, s[32:35], 0 offen offset:3072 sc1
  v_mul_f32 v92, v92, v26
  v_mul_f32 v93, v93, v26
  v_mul_f32 v94, v94, v26
  v_mul_f32 v95, v95, v26
  v_mul_f32 v96, v96, v26
  v_mul_f32 v97, v97, v26
  v_mul_f32 v98, v98, v26
  v_mul_f32 v99, v99, v26
  v_mul_f32 v100, v100, v26
  v_mul_f32 v101, v101, v26
  v_mul_f32 v102, v102, v26
  v_mul_f32 v103, v103, v26
  v_mul_f32 v104, v104, v26
  v_mul_f32 v105, v105, v26
  v_mul_f32 v106, v106, v26
  v_mul_f32 v107, v107, v26
  v_mul_f32 v108, v108, v26
  v_mul_f32 v109, v109, v26
  v_mul_f32 v110, v110, v26
  v_mul_f32 v111, v111, v26
  v_mul_f32 v112, v112, v26
  v_mul_f32 v113, v113, v26
  v_mul_f32 v114, v114, v26
  v_mul_f32 v115, v115, v26
  v_mul_f32 v116, v116, v26
  v_mul_f32 v117, v117, v26
  v_mul_f32 v118, v118, v26
  v_mul_f32 v119, v119, v26
  v_mul_f32 v120, v120, v26
  v_mul_f32 v121, v121, v26
  v_mul_f32 v122, v122, v26
  v_mul_f32 v123, v123, v26
  v_cvt_pk_bf16_f32 v44, v92, v93
  v_cvt_pk_bf16_f32 v45, v94, v95
  v_cvt_pk_bf16_f32 v46, v96, v97
  v_cvt_pk_bf16_f32 v47, v98, v99
  v_cvt_pk_bf16_f32 v48, v100, v101
  v_cvt_pk_bf16_f32 v49, v102, v103
  v_cvt_pk_bf16_f32 v50, v104, v105
  v_cvt_pk_bf16_f32 v51, v106, v107
  v_cvt_pk_bf16_f32 v52, v108, v109
  v_cvt_pk_bf16_f32 v53, v110, v111
  v_cvt_pk_bf16_f32 v54, v112, v113
  v_cvt_pk_bf16_f32 v55, v114, v115
  v_cvt_pk_bf16_f32 v56, v116, v117
  v_cvt_pk_bf16_f32 v57, v118, v119
  v_cvt_pk_bf16_f32 v58, v120, v121
  v_cvt_pk_bf16_f32 v59, v122, v123
  s_nop 1
  v_permlane16_swap_b32 v44, v46
  v_permlane16_swap_b32 v45, v47
  v_permlane16_swap_b32 v48, v50
  v_permlane16_swap_b32 v49, v51
  v_permlane16_swap_b32 v52, v54
  v_permlane16_swap_b32 v53, v55
  v_permlane16_swap_b32 v56, v58
  v_permlane16_swap_b32 v57, v59
  buffer_store_dwordx4 v[44:47], v4, s[32:35], s47 offen offset:0 sc1
  buffer_store_dwordx4 v[48:51], v4, s[32:35], s47 offen offset:1024 sc1
  buffer_store_dwordx4 v[52:55], v4, s[32:35], s47 offen offset:2048 sc1
  buffer_store_dwordx4 v[56:59], v4, s[32:35], s47 offen offset:3072 sc1
  s_lshr_b32 s42, s38, 2
  s_and_b32 s43, s38, 3
  s_lshl_b32 s41, s40, 7
  s_lshl_b32 s3, s42, 4
  s_add_u32 s41, s41, s3
  s_lshl_b32 s41, s41, 10
  s_add_u32 s28, s12, s41
  s_addc_u32 s29, s13, 0
  s_mov_b32 s30, 147456
  s_mov_b32 s31, 0x00020000
  v_bfe_u32 v24, v0, 2, 2
  v_and_b32 v25, 3, v0
  v_and_b32 v26, 1, v2
  v_lshl_add_u32 v27, v26, 4, v24
  v_lshrrev_b32 v3, 1, v2
  v_lshl_add_u32 v27, v3, 3, v27
  v_lshl_add_u32 v26, v26, 2, v24
  v_lshlrev_b32 v27, 8, v27
  v_lshrrev_b32 v3, 1, v25
  v_lshl_add_u32 v27, v3, 4, v27
  v_and_b32 v3, 1, v25
  v_lshl_add_u32 v27, v3, 3, v27
  v_xor_b32 v3, 0, v26
  v_lshl_add_u32 v14, v3, 5, v27
  v_xor_b32 v3, 1, v26
  v_lshl_add_u32 v15, v3, 5, v27
  v_xor_b32 v3, 2, v26
  v_lshl_add_u32 v16, v3, 5, v27
  v_xor_b32 v3, 3, v26
  v_lshl_add_u32 v17, v3, 5, v27
  v_xor_b32 v3, 4, v26
  v_lshl_add_u32 v18, v3, 5, v27
  v_xor_b32 v3, 5, v26
  v_lshl_add_u32 v19, v3, 5, v27
  v_xor_b32 v3, 6, v26
  v_lshl_add_u32 v20, v3, 5, v27
  v_xor_b32 v3, 7, v26
  v_lshl_add_u32 v21, v3, 5, v27
  s_lshl_b32 s3, s43, 15
  v_add_u32 v14, s3, v14
  v_add_u32 v15, s3, v15
  v_add_u32 v16, s3, v16
  v_add_u32 v17, s3, v17
  v_add_u32 v18, s3, v18
  v_add_u32 v19, s3, v19
  v_add_u32 v20, s3, v20
  v_add_u32 v21, s3, v21
  v_mov_b32 v60, 0
  v_mov_b32 v61, 0
  v_mov_b32 v62, 0
  v_mov_b32 v63, 0
  v_mov_b32 v64, 0
  v_mov_b32 v65, 0
  v_mov_b32 v66, 0
  v_mov_b32 v67, 0
  v_mov_b32 v68, 0
  v_mov_b32 v69, 0
  v_mov_b32 v70, 0
  v_mov_b32 v71, 0
  v_mov_b32 v72, 0
  v_mov_b32 v73, 0
  v_mov_b32 v74, 0
  v_mov_b32 v75, 0
  v_mov_b32 v76, 0
  v_mov_b32 v77, 0
  v_mov_b32 v78, 0
  v_mov_b32 v79, 0
  v_mov_b32 v80, 0
  v_mov_b32 v81, 0
  v_mov_b32 v82, 0
  v_mov_b32 v83, 0
  v_mov_b32 v84, 0
  v_mov_b32 v85, 0
  v_mov_b32 v86, 0
  v_mov_b32 v87, 0
  v_mov_b32 v88, 0
  v_mov_b32 v89, 0
  v_mov_b32 v90, 0
  v_mov_b32 v91, 0
  v_mov_b32 v92, 0
  v_mov_b32 v93, 0
  v_mov_b32 v94, 0
  v_mov_b32 v95, 0
  v_mov_b32 v96, 0
  v_mov_b32 v97, 0
  v_mov_b32 v98, 0
  v_mov_b32 v99, 0
  v_mov_b32 v100, 0
  v_mov_b32 v101, 0
  v_mov_b32 v102, 0
  v_mov_b32 v103, 0
  v_mov_b32 v104, 0
  v_mov_b32 v105, 0
  v_mov_b32 v106, 0
  v_mov_b32 v107, 0
  v_mov_b32 v108, 0
  v_mov_b32 v109, 0
  v_mov_b32 v110, 0
  v_mov_b32 v111, 0
  v_mov_b32 v112, 0
  v_mov_b32 v113, 0
  v_mov_b32 v114, 0
  v_mov_b32 v115, 0
  v_mov_b32 v116, 0
  v_mov_b32 v117, 0
  v_mov_b32 v118, 0
  v_mov_b32 v119, 0
  v_mov_b32 v120, 0
  v_mov_b32 v121, 0
  v_mov_b32 v122, 0
  v_mov_b32 v123, 0
  s_lshl_b32 s3, s37, 2
  s_add_u32 s3, s3, s43
  s_lshl_b32 s41, s42, 5
  s_add_u32 s41, s41, s3
  s_mul_i32 s41, s41, 9
  s_add_u32 s41, s41, s45
  s_lshl_b32 s41, s41, 13
  s_add_u32 s41, s41, 16777216
  s_add_u32 s20, s12, s41
  s_addc_u32 s21, s13, 0
  s_mov_b32 s22, 16384
  s_mov_b32 s23, 0x00020000
  s_mul_i32 s41, s3, 9
  s_add_u32 s41, s41, s45
  s_lshl_b32 s41, s41, 3
  s_add_u32 s41, s41, s42
  s_lshl_b32 s41, s41, 10
  s_add_u32 s41, s41, 16777216
  s_add_u32 s24, s12, s41
  s_addc_u32 s25, s13, 0
  s_mov_b32 s26, 16524288
  s_mov_b32 s27, 0x00020000
  s_mul_i32 s41, s37, 144
  s_lshl_b32 s39, s45, 4
  s_add_u32 s41, s41, s39
  s_lshl_b32 s41, s41, 10
  s_lshl_b32 s39, s43, 8
  s_add_u32 s41, s41, s39
  s_lshl_b32 s39, s42, 5
  s_add_u32 s41, s41, s39
  s_add_u32 s16, s74, s41
  s_addc_u32 s17, s75, 0
  s_sub_u32 s18, 1179648, s41
  s_mov_b32 s19, 0x00020000
  v_lshlrev_b32 v6, 10, v1
  v_lshl_add_u32 v6, v2, 3, v6
  v_add_u32 v7, 16384, v6
  s_waitcnt vmcnt(0)
  s_barrier
  ds_read_b64_tr_b16 v[168:169], v14 offset:0
  ds_read_b64_tr_b16 v[170:171], v14 offset:1024
  ds_read_b64_tr_b16 v[172:173], v15 offset:0
  ds_read_b64_tr_b16 v[174:175], v15 offset:1024
  ds_read_b64_tr_b16 v[176:177], v16 offset:0
  ds_read_b64_tr_b16 v[178:179], v16 offset:1024
  ds_read_b64_tr_b16 v[180:181], v17 offset:0
  ds_read_b64_tr_b16 v[182:183], v17 offset:1024
  ds_read_b64_tr_b16 v[184:185], v18 offset:0
  ds_read_b64_tr_b16 v[186:187], v18 offset:1024
  ds_read_b64_tr_b16 v[188:189], v19 offset:0
  ds_read_b64_tr_b16 v[190:191], v19 offset:1024
  ds_read_b64_tr_b16 v[192:193], v20 offset:0
  ds_read_b64_tr_b16 v[194:195], v20 offset:1024
  ds_read_b64_tr_b16 v[196:197], v21 offset:0
  ds_read_b64_tr_b16 v[198:199], v21 offset:1024
  s_waitcnt lgkmcnt(12)
  v_mfma_f32_16x16x32_bf16 v[60:63], v[168:171], v[28:31], v[60:63]
  v_mfma_f32_16x16x32_bf16 v[92:95], v[168:171], v[44:47], v[92:95]
  ds_read_b64_tr_b16 v[168:169], v14 offset:8192
  ds_read_b64_tr_b16 v[170:171], v14 offset:9216
  v_mfma_f32_16x16x32_bf16 v[64:67], v[172:175], v[28:31], v[64:67]
  v_mfma_f32_16x16x32_bf16 v[96:99], v[172:175], v[44:47], v[96:99]
  ds_read_b64_tr_b16 v[172:173], v15 offset:8192
  ds_read_b64_tr_b16 v[174:175], v15 offset:9216
  s_waitcnt lgkmcnt(12)
  v_mfma_f32_16x16x32_bf16 v[68:71], v[176:179], v[28:31], v[68:71]
  v_mfma_f32_16x16x32_bf16 v[100:103], v[176:179], v[44:47], v[100:103]
  ds_read_b64_tr_b16 v[176:177], v16 offset:8192
  ds_read_b64_tr_b16 v[178:179], v16 offset:9216
  v_mfma_f32_16x16x32_bf16 v[72:75], v[180:183], v[28:31], v[72:75]
  v_mfma_f32_16x16x32_bf16 v[104:107], v[180:183], v[44:47], v[104:107]
  ds_read_b64_tr_b16 v[180:181], v17 offset:8192
  ds_read_b64_tr_b16 v[182:183], v17 offset:9216
  s_waitcnt lgkmcnt(12)
  v_mfma_f32_16x16x32_bf16 v[76:79], v[184:187], v[28:31], v[76:79]
  v_mfma_f32_16x16x32_bf16 v[108:111], v[184:187], v[44:47], v[108:111]
  ds_read_b64_tr_b16 v[184:185], v18 offset:8192
  ds_read_b64_tr_b16 v[186:187], v18 offset:9216
  v_mfma_f32_16x16x32_bf16 v[80:83], v[188:191], v[28:31], v[80:83]
  v_mfma_f32_16x16x32_bf16 v[112:115], v[188:191], v[44:47], v[112:115]
  ds_read_b64_tr_b16 v[188:189], v19 offset:8192
  ds_read_b64_tr_b16 v[190:191], v19 offset:9216
  s_waitcnt lgkmcnt(12)
  v_mfma_f32_16x16x32_bf16 v[84:87], v[192:195], v[28:31], v[84:87]
  v_mfma_f32_16x16x32_bf16 v[116:119], v[192:195], v[44:47], v[116:119]
  ds_read_b64_tr_b16 v[192:193], v20 offset:8192
  ds_read_b64_tr_b16 v[194:195], v20 offset:9216
  v_mfma_f32_16x16x32_bf16 v[88:91], v[196:199], v[28:31], v[88:91]
  v_mfma_f32_16x16x32_bf16 v[120:123], v[196:199], v[44:47], v[120:123]
  ds_read_b64_tr_b16 v[196:197], v21 offset:8192
  ds_read_b64_tr_b16 v[198:199], v21 offset:9216
  s_waitcnt lgkmcnt(12)
  v_mfma_f32_16x16x32_bf16 v[60:63], v[168:171], v[32:35], v[60:63]
  v_mfma_f32_16x16x32_bf16 v[92:95], v[168:171], v[48:51], v[92:95]
  ds_read_b64_tr_b16 v[168:169], v14 offset:16384
  ds_read_b64_tr_b16 v[170:171], v14 offset:17408
  v_mfma_f32_16x16x32_bf16 v[64:67], v[172:175], v[32:35], v[64:67]
  v_mfma_f32_16x16x32_bf16 v[96:99], v[172:175], v[48:51], v[96:99]
  ds_read_b64_tr_b16 v[172:173], v15 offset:16384
  ds_read_b64_tr_b16 v[174:175], v15 offset:17408
  s_waitcnt lgkmcnt(12)
  v_mfma_f32_16x16x32_bf16 v[68:71], v[176:179], v[32:35], v[68:71]
  v_mfma_f32_16x16x32_bf16 v[100:103], v[176:179], v[48:51], v[100:103]
  ds_read_b64_tr_b16 v[176:177], v16 offset:16384
  ds_read_b64_tr_b16 v[178:179], v16 offset:17408
  v_mfma_f32_16x16x32_bf16 v[72:75], v[180:183], v[32:35], v[72:75]
  v_mfma_f32_16x16x32_bf16 v[104:107], v[180:183], v[48:51], v[104:107]
  ds_read_b64_tr_b16 v[180:181], v17 offset:16384
  ds_read_b64_tr_b16 v[182:183], v17 offset:17408
  s_waitcnt lgkmcnt(12)
  v_mfma_f32_16x16x32_bf16 v[76:79], v[184:187], v[32:35], v[76:79]
  v_mfma_f32_16x16x32_bf16 v[108:111], v[184:187], v[48:51], v[108:111]
  ds_read_b64_tr_b16 v[184:185], v18 offset:16384
  ds_read_b64_tr_b16 v[186:187], v18 offset:17408
  v_mfma_f32_16x16x32_bf16 v[80:83], v[188:191], v[32:35], v[80:83]
  v_mfma_f32_16x16x32_bf16 v[112:115], v[188:191], v[48:51], v[112:115]
  ds_read_b64_tr_b16 v[188:189], v19 offset:16384
  ds_read_b64_tr_b16 v[190:191], v19 offset:17408
  s_waitcnt lgkmcnt(12)
  v_mfma_f32_16x16x32_bf16 v[84:87], v[192:195], v[32:35], v[84:87]
  v_mfma_f32_16x16x32_bf16 v[116:119], v[192:195], v[48:51], v[116:119]
  ds_read_b64_tr_b16 v[192:193], v20 offset:16384
  ds_read_b64_tr_b16 v[194:195], v20 offset:17408
  v_mfma_f32_16x16x32_bf16 v[88:91], v[196:199], v[32:35], v[88:91]
  v_mfma_f32_16x16x32_bf16 v[120:123], v[196:199], v[48:51], v[120:123]
  ds_read_b64_tr_b16 v[196:197], v21 offset:16384
  ds_read_b64_tr_b16 v[198:199], v21 offset:17408
  s_waitcnt lgkmcnt(12)
  v_mfma_f32_16x16x32_bf16 v[60:63], v[168:171], v[36:39], v[60:63]
  v_mfma_f32_16x16x32_bf16 v[92:95], v[168:171], v[52:55], v[92:95]
  ds_read_b64_tr_b16 v[168:169], v14 offset:24576
  ds_read_b64_tr_b16 v[170:171], v14 offset:25600
  v_mfma_f32_16x16x32_bf16 v[64:67], v[172:175], v[36:39], v[64:67]
  v_mfma_f32_16x16x32_bf16 v[96:99], v[172:175], v[52:55], v[96:99]
  ds_read_b64_tr_b16 v[172:173], v15 offset:24576
  ds_read_b64_tr_b16 v[174:175], v15 offset:25600
  s_waitcnt lgkmcnt(12)
  v_mfma_f32_16x16x32_bf16 v[68:71], v[176:179], v[36:39], v[68:71]
  v_mfma_f32_16x16x32_bf16 v[100:103], v[176:179], v[52:55], v[100:103]
  ds_read_b64_tr_b16 v[176:177], v16 offset:24576
  ds_read_b64_tr_b16 v[178:179], v16 offset:25600
  v_mfma_f32_16x16x32_bf16 v[72:75], v[180:183], v[36:39], v[72:75]
  v_mfma_f32_16x16x32_bf16 v[104:107], v[180:183], v[52:55], v[104:107]
  ds_read_b64_tr_b16 v[180:181], v17 offset:24576
  ds_read_b64_tr_b16 v[182:183], v17 offset:25600
  s_waitcnt lgkmcnt(12)
  v_mfma_f32_16x16x32_bf16 v[76:79], v[184:187], v[36:39], v[76:79]
  v_mfma_f32_16x16x32_bf16 v[108:111], v[184:187], v[52:55], v[108:111]
  ds_read_b64_tr_b16 v[184:185], v18 offset:24576
  ds_read_b64_tr_b16 v[186:187], v18 offset:25600
  v_mfma_f32_16x16x32_bf16 v[80:83], v[188:191], v[36:39], v[80:83]
  v_mfma_f32_16x16x32_bf16 v[112:115], v[188:191], v[52:55], v[112:115]
  ds_read_b64_tr_b16 v[188:189], v19 offset:24576
  ds_read_b64_tr_b16 v[190:191], v19 offset:25600
  s_waitcnt lgkmcnt(12)
  v_mfma_f32_16x16x32_bf16 v[84:87], v[192:195], v[36:39], v[84:87]
  v_mfma_f32_16x16x32_bf16 v[116:119], v[192:195], v[52:55], v[116:119]
  ds_read_b64_tr_b16 v[192:193], v20 offset:24576
  ds_read_b64_tr_b16 v[194:195], v20 offset:25600
  v_mfma_f32_16x16x32_bf16 v[88:91], v[196:199], v[36:39], v[88:91]
  v_mfma_f32_16x16x32_bf16 v[120:123], v[196:199], v[52:55], v[120:123]
  ds_read_b64_tr_b16 v[196:197], v21 offset:24576
  ds_read_b64_tr_b16 v[198:199], v21 offset:25600
  s_waitcnt lgkmcnt(12)
  v_mfma_f32_16x16x32_bf16 v[60:63], v[168:171], v[40:43], v[60:63]
  v_mfma_f32_16x16x32_bf16 v[92:95], v[168:171], v[56:59], v[92:95]
  v_mfma_f32_16x16x32_bf16 v[64:67], v[172:175], v[40:43], v[64:67]
  v_mfma_f32_16x16x32_bf16 v[96:99], v[172:175], v[56:59], v[96:99]
  s_waitcnt lgkmcnt(8)
  v_mfma_f32_16x16x32_bf16 v[68:71], v[176:179], v[40:43], v[68:71]
  v_mfma_f32_16x16x32_bf16 v[100:103], v[176:179], v[56:59], v[100:103]
  v_mfma_f32_16x16x32_bf16 v[72:75], v[180:183], v[40:43], v[72:75]
  v_mfma_f32_16x16x32_bf16 v[104:107], v[180:183], v[56:59], v[104:107]
  s_waitcnt lgkmcnt(4)
  v_mfma_f32_16x16x32_bf16 v[76:79], v[184:187], v[40:43], v[76:79]
  v_mfma_f32_16x16x32_bf16 v[108:111], v[184:187], v[56:59], v[108:111]
  v_mfma_f32_16x16x32_bf16 v[80:83], v[188:191], v[40:43], v[80:83]
  v_mfma_f32_16x16x32_bf16 v[112:115], v[188:191], v[56:59], v[112:115]
  s_waitcnt lgkmcnt(0)
  v_mfma_f32_16x16x32_bf16 v[84:87], v[192:195], v[40:43], v[84:87]
  v_mfma_f32_16x16x32_bf16 v[116:119], v[192:195], v[56:59], v[116:119]
  v_mfma_f32_16x16x32_bf16 v[88:91], v[196:199], v[40:43], v[88:91]
  v_mfma_f32_16x16x32_bf16 v[120:123], v[196:199], v[56:59], v[120:123]
  s_barrier
  s_add_u32 s3, s43, 1
  s_and_b32 s3, s3, 3
  s_lshl_b32 s64, s3, 12
  s_add_u32 s68, s64, 131072
  s_add_u32 s3, s43, 2
  s_and_b32 s3, s3, 3
  s_lshl_b32 s65, s3, 12
  s_add_u32 s69, s65, 131072
  s_add_u32 s3, s43, 3
  s_and_b32 s3, s3, 3
  s_lshl_b32 s66, s3, 12
  s_add_u32 s70, s66, 131072
  buffer_load_dwordx4 v[44:47], v4, s[28:31], s64 offen offset:0 sc1
  buffer_load_dwordx4 v[48:51], v4, s[28:31], s64 offen offset:1024 sc1
  buffer_load_dwordx4 v[52:55], v4, s[28:31], s64 offen offset:2048 sc1
  buffer_load_dwordx4 v[56:59], v4, s[28:31], s64 offen offset:3072 sc1
  buffer_load_dwordx4 v[204:207], v4, s[28:31], s68 offen offset:0 sc1
  buffer_load_dwordx4 v[208:211], v4, s[28:31], s68 offen offset:1024 sc1
  buffer_load_dwordx4 v[212:215], v4, s[28:31], s68 offen offset:2048 sc1
  buffer_load_dwordx4 v[216:219], v4, s[28:31], s68 offen offset:3072 sc1
  buffer_load_dwordx4 v[124:127], v4, s[28:31], s65 offen offset:0 sc1
  buffer_load_dwordx4 v[128:131], v4, s[28:31], s65 offen offset:1024 sc1
  buffer_load_dwordx4 v[132:135], v4, s[28:31], s65 offen offset:2048 sc1
  buffer_load_dwordx4 v[136:139], v4, s[28:31], s65 offen offset:3072 sc1
  buffer_load_dwordx4 v[220:223], v4, s[28:31], s69 offen offset:0 sc1
  buffer_load_dwordx4 v[224:227], v4, s[28:31], s69 offen offset:1024 sc1
  buffer_load_dwordx4 v[228:231], v4, s[28:31], s69 offen offset:2048 sc1
  buffer_load_dwordx4 v[232:235], v4, s[28:31], s69 offen offset:3072 sc1
  buffer_load_dwordx4 v[140:143], v4, s[28:31], s66 offen offset:0 sc1
  buffer_load_dwordx4 v[144:147], v4, s[28:31], s66 offen offset:1024 sc1
  buffer_load_dwordx4 v[148:151], v4, s[28:31], s66 offen offset:2048 sc1
  buffer_load_dwordx4 v[152:155], v4, s[28:31], s66 offen offset:3072 sc1
  buffer_load_dwordx4 v[236:239], v4, s[28:31], s70 offen offset:0 sc1
  buffer_load_dwordx4 v[240:243], v4, s[28:31], s70 offen offset:1024 sc1
  buffer_load_dwordx4 v[244:247], v4, s[28:31], s70 offen offset:2048 sc1
  buffer_load_dwordx4 v[248:251], v4, s[28:31], s70 offen offset:3072 sc1
  s_add_u32 s3, s43, 1
  s_and_b32 s3, s3, 3
  s_cmp_eq_u32 s3, 0
  s_mov_b32 s39, 0x8000
  s_cselect_b32 s3, 0xfffe8000, s39
  v_add_u32 v14, s3, v14
  v_add_u32 v15, s3, v15
  v_add_u32 v16, s3, v16
  v_add_u32 v17, s3, v17
  v_add_u32 v18, s3, v18
  v_add_u32 v19, s3, v19
  v_add_u32 v20, s3, v20
  v_add_u32 v21, s3, v21
  s_waitcnt vmcnt(16)
  ds_read_b64_tr_b16 v[168:169], v14 offset:0
  ds_read_b64_tr_b16 v[170:171], v14 offset:1024
  ds_read_b64_tr_b16 v[172:173], v15 offset:0
  ds_read_b64_tr_b16 v[174:175], v15 offset:1024
  ds_read_b64_tr_b16 v[176:177], v16 offset:0
  ds_read_b64_tr_b16 v[178:179], v16 offset:1024
  ds_read_b64_tr_b16 v[180:181], v17 offset:0
  ds_read_b64_tr_b16 v[182:183], v17 offset:1024
  ds_read_b64_tr_b16 v[184:185], v18 offset:0
  ds_read_b64_tr_b16 v[186:187], v18 offset:1024
  ds_read_b64_tr_b16 v[188:189], v19 offset:0
  ds_read_b64_tr_b16 v[190:191], v19 offset:1024
  ds_read_b64_tr_b16 v[192:193], v20 offset:0
  ds_read_b64_tr_b16 v[194:195], v20 offset:1024
  ds_read_b64_tr_b16 v[196:197], v21 offset:0
  ds_read_b64_tr_b16 v[198:199], v21 offset:1024
  s_waitcnt lgkmcnt(12)
  v_mfma_f32_16x16x32_bf16 v[60:63], v[168:171], v[44:47], v[60:63]
  v_mfma_f32_16x16x32_bf16 v[92:95], v[168:171], v[204:207], v[92:95]
  ds_read_b64_tr_b16 v[168:169], v14 offset:8192
  ds_read_b64_tr_b16 v[170:171], v14 offset:9216
  v_mfma_f32_16x16x32_bf16 v[64:67], v[172:175], v[44:47], v[64:67]
  v_mfma_f32_16x16x32_bf16 v[96:99], v[172:175], v[204:207], v[96:99]
  ds_read_b64_tr_b16 v[172:173], v15 offset:8192
  ds_read_b64_tr_b16 v[174:175], v15 offset:9216
  s_waitcnt lgkmcnt(12)
  v_mfma_f32_16x16x32_bf16 v[68:71], v[176:179], v[44:47], v[68:71]
  v_mfma_f32_16x16x32_bf16 v[100:103], v[176:179], v[204:207], v[100:103]
  ds_read_b64_tr_b16 v[176:177], v16 offset:8192
  ds_read_b64_tr_b16 v[178:179], v16 offset:9216
  v_mfma_f32_16x16x32_bf16 v[72:75], v[180:183], v[44:47], v[72:75]
  v_mfma_f32_16x16x32_bf16 v[104:107], v[180:183], v[204:207], v[104:107]
  ds_read_b64_tr_b16 v[180:181], v17 offset:8192
  ds_read_b64_tr_b16 v[182:183], v17 offset:9216
  s_waitcnt lgkmcnt(12)
  v_mfma_f32_16x16x32_bf16 v[76:79], v[184:187], v[44:47], v[76:79]
  v_mfma_f32_16x16x32_bf16 v[108:111], v[184:187], v[204:207], v[108:111]
  ds_read_b64_tr_b16 v[184:185], v18 offset:8192
  ds_read_b64_tr_b16 v[186:187], v18 offset:9216
  v_mfma_f32_16x16x32_bf16 v[80:83], v[188:191], v[44:47], v[80:83]
  v_mfma_f32_16x16x32_bf16 v[112:115], v[188:191], v[204:207], v[112:115]
  ds_read_b64_tr_b16 v[188:189], v19 offset:8192
  ds_read_b64_tr_b16 v[190:191], v19 offset:9216
  s_waitcnt lgkmcnt(12)
  v_mfma_f32_16x16x32_bf16 v[84:87], v[192:195], v[44:47], v[84:87]
  v_mfma_f32_16x16x32_bf16 v[116:119], v[192:195], v[204:207], v[116:119]
  ds_read_b64_tr_b16 v[192:193], v20 offset:8192
  ds_read_b64_tr_b16 v[194:195], v20 offset:9216
  v_mfma_f32_16x16x32_bf16 v[88:91], v[196:199], v[44:47], v[88:91]
  v_mfma_f32_16x16x32_bf16 v[120:123], v[196:199], v[204:207], v[120:123]
  ds_read_b64_tr_b16 v[196:197], v21 offset:8192
  ds_read_b64_tr_b16 v[198:199], v21 offset:9216
  s_waitcnt lgkmcnt(12)
  v_mfma_f32_16x16x32_bf16 v[60:63], v[168:171], v[48:51], v[60:63]
  v_mfma_f32_16x16x32_bf16 v[92:95], v[168:171], v[208:211], v[92:95]
  ds_read_b64_tr_b16 v[168:169], v14 offset:16384
  ds_read_b64_tr_b16 v[170:171], v14 offset:17408
  v_mfma_f32_16x16x32_bf16 v[64:67], v[172:175], v[48:51], v[64:67]
  v_mfma_f32_16x16x32_bf16 v[96:99], v[172:175], v[208:211], v[96:99]
  ds_read_b64_tr_b16 v[172:173], v15 offset:16384
  ds_read_b64_tr_b16 v[174:175], v15 offset:17408
  s_waitcnt lgkmcnt(12)
  v_mfma_f32_16x16x32_bf16 v[68:71], v[176:179], v[48:51], v[68:71]
  v_mfma_f32_16x16x32_bf16 v[100:103], v[176:179], v[208:211], v[100:103]
  ds_read_b64_tr_b16 v[176:177], v16 offset:16384
  ds_read_b64_tr_b16 v[178:179], v16 offset:17408
  v_mfma_f32_16x16x32_bf16 v[72:75], v[180:183], v[48:51], v[72:75]
  v_mfma_f32_16x16x32_bf16 v[104:107], v[180:183], v[208:211], v[104:107]
  ds_read_b64_tr_b16 v[180:181], v17 offset:16384
  ds_read_b64_tr_b16 v[182:183], v17 offset:17408
  s_waitcnt lgkmcnt(12)
  v_mfma_f32_16x16x32_bf16 v[76:79], v[184:187], v[48:51], v[76:79]
  v_mfma_f32_16x16x32_bf16 v[108:111], v[184:187], v[208:211], v[108:111]
  ds_read_b64_tr_b16 v[184:185], v18 offset:16384
  ds_read_b64_tr_b16 v[186:187], v18 offset:17408
  v_mfma_f32_16x16x32_bf16 v[80:83], v[188:191], v[48:51], v[80:83]
  v_mfma_f32_16x16x32_bf16 v[112:115], v[188:191], v[208:211], v[112:115]
  ds_read_b64_tr_b16 v[188:189], v19 offset:16384
  ds_read_b64_tr_b16 v[190:191], v19 offset:17408
  s_waitcnt lgkmcnt(12)
  v_mfma_f32_16x16x32_bf16 v[84:87], v[192:195], v[48:51], v[84:87]
  v_mfma_f32_16x16x32_bf16 v[116:119], v[192:195], v[208:211], v[116:119]
  ds_read_b64_tr_b16 v[192:193], v20 offset:16384
  ds_read_b64_tr_b16 v[194:195], v20 offset:17408
  v_mfma_f32_16x16x32_bf16 v[88:91], v[196:199], v[48:51], v[88:91]
  v_mfma_f32_16x16x32_bf16 v[120:123], v[196:199], v[208:211], v[120:123]
  ds_read_b64_tr_b16 v[196:197], v21 offset:16384
  ds_read_b64_tr_b16 v[198:199], v21 offset:17408
  s_waitcnt lgkmcnt(12)
  v_mfma_f32_16x16x32_bf16 v[60:63], v[168:171], v[52:55], v[60:63]
  v_mfma_f32_16x16x32_bf16 v[92:95], v[168:171], v[212:215], v[92:95]
  ds_read_b64_tr_b16 v[168:169], v14 offset:24576
  ds_read_b64_tr_b16 v[170:171], v14 offset:25600
  v_mfma_f32_16x16x32_bf16 v[64:67], v[172:175], v[52:55], v[64:67]
  v_mfma_f32_16x16x32_bf16 v[96:99], v[172:175], v[212:215], v[96:99]
  ds_read_b64_tr_b16 v[172:173], v15 offset:24576
  ds_read_b64_tr_b16 v[174:175], v15 offset:25600
  s_waitcnt lgkmcnt(12)
  v_mfma_f32_16x16x32_bf16 v[68:71], v[176:179], v[52:55], v[68:71]
  v_mfma_f32_16x16x32_bf16 v[100:103], v[176:179], v[212:215], v[100:103]
  ds_read_b64_tr_b16 v[176:177], v16 offset:24576
  ds_read_b64_tr_b16 v[178:179], v16 offset:25600
  v_mfma_f32_16x16x32_bf16 v[72:75], v[180:183], v[52:55], v[72:75]
  v_mfma_f32_16x16x32_bf16 v[104:107], v[180:183], v[212:215], v[104:107]
  ds_read_b64_tr_b16 v[180:181], v17 offset:24576
  ds_read_b64_tr_b16 v[182:183], v17 offset:25600
  s_waitcnt lgkmcnt(12)
  v_mfma_f32_16x16x32_bf16 v[76:79], v[184:187], v[52:55], v[76:79]
  v_mfma_f32_16x16x32_bf16 v[108:111], v[184:187], v[212:215], v[108:111]
  ds_read_b64_tr_b16 v[184:185], v18 offset:24576
  ds_read_b64_tr_b16 v[186:187], v18 offset:25600
  v_mfma_f32_16x16x32_bf16 v[80:83], v[188:191], v[52:55], v[80:83]
  v_mfma_f32_16x16x32_bf16 v[112:115], v[188:191], v[212:215], v[112:115]
  ds_read_b64_tr_b16 v[188:189], v19 offset:24576
  ds_read_b64_tr_b16 v[190:191], v19 offset:25600
  s_waitcnt lgkmcnt(12)
  v_mfma_f32_16x16x32_bf16 v[84:87], v[192:195], v[52:55], v[84:87]
  v_mfma_f32_16x16x32_bf16 v[116:119], v[192:195], v[212:215], v[116:119]
  ds_read_b64_tr_b16 v[192:193], v20 offset:24576
  ds_read_b64_tr_b16 v[194:195], v20 offset:25600
  v_mfma_f32_16x16x32_bf16 v[88:91], v[196:199], v[52:55], v[88:91]
  v_mfma_f32_16x16x32_bf16 v[120:123], v[196:199], v[212:215], v[120:123]
  ds_read_b64_tr_b16 v[196:197], v21 offset:24576
  ds_read_b64_tr_b16 v[198:199], v21 offset:25600
  s_waitcnt lgkmcnt(12)
  v_mfma_f32_16x16x32_bf16 v[60:63], v[168:171], v[56:59], v[60:63]
  v_mfma_f32_16x16x32_bf16 v[92:95], v[168:171], v[216:219], v[92:95]
  v_mfma_f32_16x16x32_bf16 v[64:67], v[172:175], v[56:59], v[64:67]
  v_mfma_f32_16x16x32_bf16 v[96:99], v[172:175], v[216:219], v[96:99]
  s_waitcnt lgkmcnt(8)
  v_mfma_f32_16x16x32_bf16 v[68:71], v[176:179], v[56:59], v[68:71]
  v_mfma_f32_16x16x32_bf16 v[100:103], v[176:179], v[216:219], v[100:103]
  v_mfma_f32_16x16x32_bf16 v[72:75], v[180:183], v[56:59], v[72:75]
  v_mfma_f32_16x16x32_bf16 v[104:107], v[180:183], v[216:219], v[104:107]
  s_waitcnt lgkmcnt(4)
  v_mfma_f32_16x16x32_bf16 v[76:79], v[184:187], v[56:59], v[76:79]
  v_mfma_f32_16x16x32_bf16 v[108:111], v[184:187], v[216:219], v[108:111]
  v_mfma_f32_16x16x32_bf16 v[80:83], v[188:191], v[56:59], v[80:83]
  v_mfma_f32_16x16x32_bf16 v[112:115], v[188:191], v[216:219], v[112:115]
  s_waitcnt lgkmcnt(0)
  v_mfma_f32_16x16x32_bf16 v[84:87], v[192:195], v[56:59], v[84:87]
  v_mfma_f32_16x16x32_bf16 v[116:119], v[192:195], v[216:219], v[116:119]
  v_mfma_f32_16x16x32_bf16 v[88:91], v[196:199], v[56:59], v[88:91]
  v_mfma_f32_16x16x32_bf16 v[120:123], v[196:199], v[216:219], v[120:123]
  s_add_u32 s3, s43, 2
  s_and_b32 s3, s3, 3
  s_cmp_eq_u32 s3, 0
  s_mov_b32 s39, 0x8000
  s_cselect_b32 s3, 0xfffe8000, s39
  v_add_u32 v14, s3, v14
  v_add_u32 v15, s3, v15
  v_add_u32 v16, s3, v16
  v_add_u32 v17, s3, v17
  v_add_u32 v18, s3, v18
  v_add_u32 v19, s3, v19
  v_add_u32 v20, s3, v20
  v_add_u32 v21, s3, v21
  s_waitcnt vmcnt(8)
  ds_read_b64_tr_b16 v[168:169], v14 offset:0
  ds_read_b64_tr_b16 v[170:171], v14 offset:1024
  ds_read_b64_tr_b16 v[172:173], v15 offset:0
  ds_read_b64_tr_b16 v[174:175], v15 offset:1024
  ds_read_b64_tr_b16 v[176:177], v16 offset:0
  ds_read_b64_tr_b16 v[178:179], v16 offset:1024
  ds_read_b64_tr_b16 v[180:181], v17 offset:0
  ds_read_b64_tr_b16 v[182:183], v17 offset:1024
  ds_read_b64_tr_b16 v[184:185], v18 offset:0
  ds_read_b64_tr_b16 v[186:187], v18 offset:1024
  ds_read_b64_tr_b16 v[188:189], v19 offset:0
  ds_read_b64_tr_b16 v[190:191], v19 offset:1024
  ds_read_b64_tr_b16 v[192:193], v20 offset:0
  ds_read_b64_tr_b16 v[194:195], v20 offset:1024
  ds_read_b64_tr_b16 v[196:197], v21 offset:0
  ds_read_b64_tr_b16 v[198:199], v21 offset:1024
  s_waitcnt lgkmcnt(12)
  v_mfma_f32_16x16x32_bf16 v[60:63], v[168:171], v[124:127], v[60:63]
  v_mfma_f32_16x16x32_bf16 v[92:95], v[168:171], v[220:223], v[92:95]
  ds_read_b64_tr_b16 v[168:169], v14 offset:8192
  ds_read_b64_tr_b16 v[170:171], v14 offset:9216
  v_mfma_f32_16x16x32_bf16 v[64:67], v[172:175], v[124:127], v[64:67]
  v_mfma_f32_16x16x32_bf16 v[96:99], v[172:175], v[220:223], v[96:99]
  ds_read_b64_tr_b16 v[172:173], v15 offset:8192
  ds_read_b64_tr_b16 v[174:175], v15 offset:9216
  s_waitcnt lgkmcnt(12)
  v_mfma_f32_16x16x32_bf16 v[68:71], v[176:179], v[124:127], v[68:71]
  v_mfma_f32_16x16x32_bf16 v[100:103], v[176:179], v[220:223], v[100:103]
  ds_read_b64_tr_b16 v[176:177], v16 offset:8192
  ds_read_b64_tr_b16 v[178:179], v16 offset:9216
  v_mfma_f32_16x16x32_bf16 v[72:75], v[180:183], v[124:127], v[72:75]
  v_mfma_f32_16x16x32_bf16 v[104:107], v[180:183], v[220:223], v[104:107]
  ds_read_b64_tr_b16 v[180:181], v17 offset:8192
  ds_read_b64_tr_b16 v[182:183], v17 offset:9216
  s_waitcnt lgkmcnt(12)
  v_mfma_f32_16x16x32_bf16 v[76:79], v[184:187], v[124:127], v[76:79]
  v_mfma_f32_16x16x32_bf16 v[108:111], v[184:187], v[220:223], v[108:111]
  ds_read_b64_tr_b16 v[184:185], v18 offset:8192
  ds_read_b64_tr_b16 v[186:187], v18 offset:9216
  v_mfma_f32_16x16x32_bf16 v[80:83], v[188:191], v[124:127], v[80:83]
  v_mfma_f32_16x16x32_bf16 v[112:115], v[188:191], v[220:223], v[112:115]
  ds_read_b64_tr_b16 v[188:189], v19 offset:8192
  ds_read_b64_tr_b16 v[190:191], v19 offset:9216
  s_waitcnt lgkmcnt(12)
  v_mfma_f32_16x16x32_bf16 v[84:87], v[192:195], v[124:127], v[84:87]
  v_mfma_f32_16x16x32_bf16 v[116:119], v[192:195], v[220:223], v[116:119]
  ds_read_b64_tr_b16 v[192:193], v20 offset:8192
  ds_read_b64_tr_b16 v[194:195], v20 offset:9216
  v_mfma_f32_16x16x32_bf16 v[88:91], v[196:199], v[124:127], v[88:91]
  v_mfma_f32_16x16x32_bf16 v[120:123], v[196:199], v[220:223], v[120:123]
  ds_read_b64_tr_b16 v[196:197], v21 offset:8192
  ds_read_b64_tr_b16 v[198:199], v21 offset:9216
  s_waitcnt lgkmcnt(12)
  v_mfma_f32_16x16x32_bf16 v[60:63], v[168:171], v[128:131], v[60:63]
  v_mfma_f32_16x16x32_bf16 v[92:95], v[168:171], v[224:227], v[92:95]
  ds_read_b64_tr_b16 v[168:169], v14 offset:16384
  ds_read_b64_tr_b16 v[170:171], v14 offset:17408
  v_mfma_f32_16x16x32_bf16 v[64:67], v[172:175], v[128:131], v[64:67]
  v_mfma_f32_16x16x32_bf16 v[96:99], v[172:175], v[224:227], v[96:99]
  ds_read_b64_tr_b16 v[172:173], v15 offset:16384
  ds_read_b64_tr_b16 v[174:175], v15 offset:17408
  s_waitcnt lgkmcnt(12)
  v_mfma_f32_16x16x32_bf16 v[68:71], v[176:179], v[128:131], v[68:71]
  v_mfma_f32_16x16x32_bf16 v[100:103], v[176:179], v[224:227], v[100:103]
  ds_read_b64_tr_b16 v[176:177], v16 offset:16384
  ds_read_b64_tr_b16 v[178:179], v16 offset:17408
  v_mfma_f32_16x16x32_bf16 v[72:75], v[180:183], v[128:131], v[72:75]
  v_mfma_f32_16x16x32_bf16 v[104:107], v[180:183], v[224:227], v[104:107]
  ds_read_b64_tr_b16 v[180:181], v17 offset:16384
  ds_read_b64_tr_b16 v[182:183], v17 offset:17408
  s_waitcnt lgkmcnt(12)
  v_mfma_f32_16x16x32_bf16 v[76:79], v[184:187], v[128:131], v[76:79]
  v_mfma_f32_16x16x32_bf16 v[108:111], v[184:187], v[224:227], v[108:111]
  ds_read_b64_tr_b16 v[184:185], v18 offset:16384
  ds_read_b64_tr_b16 v[186:187], v18 offset:17408
  v_mfma_f32_16x16x32_bf16 v[80:83], v[188:191], v[128:131], v[80:83]
  v_mfma_f32_16x16x32_bf16 v[112:115], v[188:191], v[224:227], v[112:115]
  ds_read_b64_tr_b16 v[188:189], v19 offset:16384
  ds_read_b64_tr_b16 v[190:191], v19 offset:17408
  s_waitcnt lgkmcnt(12)
  v_mfma_f32_16x16x32_bf16 v[84:87], v[192:195], v[128:131], v[84:87]
  v_mfma_f32_16x16x32_bf16 v[116:119], v[192:195], v[224:227], v[116:119]
  ds_read_b64_tr_b16 v[192:193], v20 offset:16384
  ds_read_b64_tr_b16 v[194:195], v20 offset:17408
  v_mfma_f32_16x16x32_bf16 v[88:91], v[196:199], v[128:131], v[88:91]
  v_mfma_f32_16x16x32_bf16 v[120:123], v[196:199], v[224:227], v[120:123]
  ds_read_b64_tr_b16 v[196:197], v21 offset:16384
  ds_read_b64_tr_b16 v[198:199], v21 offset:17408
  s_waitcnt lgkmcnt(12)
  v_mfma_f32_16x16x32_bf16 v[60:63], v[168:171], v[132:135], v[60:63]
  v_mfma_f32_16x16x32_bf16 v[92:95], v[168:171], v[228:231], v[92:95]
  ds_read_b64_tr_b16 v[168:169], v14 offset:24576
  ds_read_b64_tr_b16 v[170:171], v14 offset:25600
  v_mfma_f32_16x16x32_bf16 v[64:67], v[172:175], v[132:135], v[64:67]
  v_mfma_f32_16x16x32_bf16 v[96:99], v[172:175], v[228:231], v[96:99]
  ds_read_b64_tr_b16 v[172:173], v15 offset:24576
  ds_read_b64_tr_b16 v[174:175], v15 offset:25600
  s_waitcnt lgkmcnt(12)
  v_mfma_f32_16x16x32_bf16 v[68:71], v[176:179], v[132:135], v[68:71]
  v_mfma_f32_16x16x32_bf16 v[100:103], v[176:179], v[228:231], v[100:103]
  ds_read_b64_tr_b16 v[176:177], v16 offset:24576
  ds_read_b64_tr_b16 v[178:179], v16 offset:25600
  v_mfma_f32_16x16x32_bf16 v[72:75], v[180:183], v[132:135], v[72:75]
  v_mfma_f32_16x16x32_bf16 v[104:107], v[180:183], v[228:231], v[104:107]
  ds_read_b64_tr_b16 v[180:181], v17 offset:24576
  ds_read_b64_tr_b16 v[182:183], v17 offset:25600
  s_waitcnt lgkmcnt(12)
  v_mfma_f32_16x16x32_bf16 v[76:79], v[184:187], v[132:135], v[76:79]
  v_mfma_f32_16x16x32_bf16 v[108:111], v[184:187], v[228:231], v[108:111]
  ds_read_b64_tr_b16 v[184:185], v18 offset:24576
  ds_read_b64_tr_b16 v[186:187], v18 offset:25600
  v_mfma_f32_16x16x32_bf16 v[80:83], v[188:191], v[132:135], v[80:83]
  v_mfma_f32_16x16x32_bf16 v[112:115], v[188:191], v[228:231], v[112:115]
  ds_read_b64_tr_b16 v[188:189], v19 offset:24576
  ds_read_b64_tr_b16 v[190:191], v19 offset:25600
  s_waitcnt lgkmcnt(12)
  v_mfma_f32_16x16x32_bf16 v[84:87], v[192:195], v[132:135], v[84:87]
  v_mfma_f32_16x16x32_bf16 v[116:119], v[192:195], v[228:231], v[116:119]
  ds_read_b64_tr_b16 v[192:193], v20 offset:24576
  ds_read_b64_tr_b16 v[194:195], v20 offset:25600
  v_mfma_f32_16x16x32_bf16 v[88:91], v[196:199], v[132:135], v[88:91]
  v_mfma_f32_16x16x32_bf16 v[120:123], v[196:199], v[228:231], v[120:123]
  ds_read_b64_tr_b16 v[196:197], v21 offset:24576
  ds_read_b64_tr_b16 v[198:199], v21 offset:25600
  s_waitcnt lgkmcnt(12)
  v_mfma_f32_16x16x32_bf16 v[60:63], v[168:171], v[136:139], v[60:63]
  v_mfma_f32_16x16x32_bf16 v[92:95], v[168:171], v[232:235], v[92:95]
  v_mfma_f32_16x16x32_bf16 v[64:67], v[172:175], v[136:139], v[64:67]
  v_mfma_f32_16x16x32_bf16 v[96:99], v[172:175], v[232:235], v[96:99]
  s_waitcnt lgkmcnt(8)
  v_mfma_f32_16x16x32_bf16 v[68:71], v[176:179], v[136:139], v[68:71]
  v_mfma_f32_16x16x32_bf16 v[100:103], v[176:179], v[232:235], v[100:103]
  v_mfma_f32_16x16x32_bf16 v[72:75], v[180:183], v[136:139], v[72:75]
  v_mfma_f32_16x16x32_bf16 v[104:107], v[180:183], v[232:235], v[104:107]
  s_waitcnt lgkmcnt(4)
  v_mfma_f32_16x16x32_bf16 v[76:79], v[184:187], v[136:139], v[76:79]
  v_mfma_f32_16x16x32_bf16 v[108:111], v[184:187], v[232:235], v[108:111]
  v_mfma_f32_16x16x32_bf16 v[80:83], v[188:191], v[136:139], v[80:83]
  v_mfma_f32_16x16x32_bf16 v[112:115], v[188:191], v[232:235], v[112:115]
  s_waitcnt lgkmcnt(0)
  v_mfma_f32_16x16x32_bf16 v[84:87], v[192:195], v[136:139], v[84:87]
  v_mfma_f32_16x16x32_bf16 v[116:119], v[192:195], v[232:235], v[116:119]
  v_mfma_f32_16x16x32_bf16 v[88:91], v[196:199], v[136:139], v[88:91]
  v_mfma_f32_16x16x32_bf16 v[120:123], v[196:199], v[232:235], v[120:123]
  s_add_u32 s3, s43, 3
  s_and_b32 s3, s3, 3
  s_cmp_eq_u32 s3, 0
  s_mov_b32 s39, 0x8000
  s_cselect_b32 s3, 0xfffe8000, s39
  v_add_u32 v14, s3, v14
  v_add_u32 v15, s3, v15
  v_add_u32 v16, s3, v16
  v_add_u32 v17, s3, v17
  v_add_u32 v18, s3, v18
  v_add_u32 v19, s3, v19
  v_add_u32 v20, s3, v20
  v_add_u32 v21, s3, v21
  s_waitcnt vmcnt(0)
  ds_read_b64_tr_b16 v[168:169], v14 offset:0
  ds_read_b64_tr_b16 v[170:171], v14 offset:1024
  ds_read_b64_tr_b16 v[172:173], v15 offset:0
  ds_read_b64_tr_b16 v[174:175], v15 offset:1024
  ds_read_b64_tr_b16 v[176:177], v16 offset:0
  ds_read_b64_tr_b16 v[178:179], v16 offset:1024
  ds_read_b64_tr_b16 v[180:181], v17 offset:0
  ds_read_b64_tr_b16 v[182:183], v17 offset:1024
  ds_read_b64_tr_b16 v[184:185], v18 offset:0
  ds_read_b64_tr_b16 v[186:187], v18 offset:1024
  ds_read_b64_tr_b16 v[188:189], v19 offset:0
  ds_read_b64_tr_b16 v[190:191], v19 offset:1024
  ds_read_b64_tr_b16 v[192:193], v20 offset:0
  ds_read_b64_tr_b16 v[194:195], v20 offset:1024
  ds_read_b64_tr_b16 v[196:197], v21 offset:0
  ds_read_b64_tr_b16 v[198:199], v21 offset:1024
  s_waitcnt lgkmcnt(12)
  v_mfma_f32_16x16x32_bf16 v[60:63], v[168:171], v[140:143], v[60:63]
  v_mfma_f32_16x16x32_bf16 v[92:95], v[168:171], v[236:239], v[92:95]
  ds_read_b64_tr_b16 v[168:169], v14 offset:8192
  ds_read_b64_tr_b16 v[170:171], v14 offset:9216
  v_mfma_f32_16x16x32_bf16 v[64:67], v[172:175], v[140:143], v[64:67]
  v_mfma_f32_16x16x32_bf16 v[96:99], v[172:175], v[236:239], v[96:99]
  ds_read_b64_tr_b16 v[172:173], v15 offset:8192
  ds_read_b64_tr_b16 v[174:175], v15 offset:9216
  s_waitcnt lgkmcnt(12)
  v_mfma_f32_16x16x32_bf16 v[68:71], v[176:179], v[140:143], v[68:71]
  v_mfma_f32_16x16x32_bf16 v[100:103], v[176:179], v[236:239], v[100:103]
  ds_read_b64_tr_b16 v[176:177], v16 offset:8192
  ds_read_b64_tr_b16 v[178:179], v16 offset:9216
  v_mfma_f32_16x16x32_bf16 v[72:75], v[180:183], v[140:143], v[72:75]
  v_mfma_f32_16x16x32_bf16 v[104:107], v[180:183], v[236:239], v[104:107]
  ds_read_b64_tr_b16 v[180:181], v17 offset:8192
  ds_read_b64_tr_b16 v[182:183], v17 offset:9216
  s_waitcnt lgkmcnt(12)
  v_mfma_f32_16x16x32_bf16 v[76:79], v[184:187], v[140:143], v[76:79]
  v_mfma_f32_16x16x32_bf16 v[108:111], v[184:187], v[236:239], v[108:111]
  ds_read_b64_tr_b16 v[184:185], v18 offset:8192
  ds_read_b64_tr_b16 v[186:187], v18 offset:9216
  v_mfma_f32_16x16x32_bf16 v[80:83], v[188:191], v[140:143], v[80:83]
  v_mfma_f32_16x16x32_bf16 v[112:115], v[188:191], v[236:239], v[112:115]
  ds_read_b64_tr_b16 v[188:189], v19 offset:8192
  ds_read_b64_tr_b16 v[190:191], v19 offset:9216
  s_waitcnt lgkmcnt(12)
  v_mfma_f32_16x16x32_bf16 v[84:87], v[192:195], v[140:143], v[84:87]
  v_mfma_f32_16x16x32_bf16 v[116:119], v[192:195], v[236:239], v[116:119]
  ds_read_b64_tr_b16 v[192:193], v20 offset:8192
  ds_read_b64_tr_b16 v[194:195], v20 offset:9216
  v_mfma_f32_16x16x32_bf16 v[88:91], v[196:199], v[140:143], v[88:91]
  v_mfma_f32_16x16x32_bf16 v[120:123], v[196:199], v[236:239], v[120:123]
  ds_read_b64_tr_b16 v[196:197], v21 offset:8192
  ds_read_b64_tr_b16 v[198:199], v21 offset:9216
  s_waitcnt lgkmcnt(12)
  v_mfma_f32_16x16x32_bf16 v[60:63], v[168:171], v[144:147], v[60:63]
  v_mfma_f32_16x16x32_bf16 v[92:95], v[168:171], v[240:243], v[92:95]
  ds_read_b64_tr_b16 v[168:169], v14 offset:16384
  ds_read_b64_tr_b16 v[170:171], v14 offset:17408
  v_mfma_f32_16x16x32_bf16 v[64:67], v[172:175], v[144:147], v[64:67]
  v_mfma_f32_16x16x32_bf16 v[96:99], v[172:175], v[240:243], v[96:99]
  ds_read_b64_tr_b16 v[172:173], v15 offset:16384
  ds_read_b64_tr_b16 v[174:175], v15 offset:17408
  s_waitcnt lgkmcnt(12)
  v_mfma_f32_16x16x32_bf16 v[68:71], v[176:179], v[144:147], v[68:71]
  v_mfma_f32_16x16x32_bf16 v[100:103], v[176:179], v[240:243], v[100:103]
  ds_read_b64_tr_b16 v[176:177], v16 offset:16384
  ds_read_b64_tr_b16 v[178:179], v16 offset:17408
  v_mfma_f32_16x16x32_bf16 v[72:75], v[180:183], v[144:147], v[72:75]
  v_mfma_f32_16x16x32_bf16 v[104:107], v[180:183], v[240:243], v[104:107]
  ds_read_b64_tr_b16 v[180:181], v17 offset:16384
  ds_read_b64_tr_b16 v[182:183], v17 offset:17408
  s_waitcnt lgkmcnt(12)
  v_mfma_f32_16x16x32_bf16 v[76:79], v[184:187], v[144:147], v[76:79]
  v_mfma_f32_16x16x32_bf16 v[108:111], v[184:187], v[240:243], v[108:111]
  ds_read_b64_tr_b16 v[184:185], v18 offset:16384
  ds_read_b64_tr_b16 v[186:187], v18 offset:17408
  v_mfma_f32_16x16x32_bf16 v[80:83], v[188:191], v[144:147], v[80:83]
  v_mfma_f32_16x16x32_bf16 v[112:115], v[188:191], v[240:243], v[112:115]
  ds_read_b64_tr_b16 v[188:189], v19 offset:16384
  ds_read_b64_tr_b16 v[190:191], v19 offset:17408
  s_waitcnt lgkmcnt(12)
  v_mfma_f32_16x16x32_bf16 v[84:87], v[192:195], v[144:147], v[84:87]
  v_mfma_f32_16x16x32_bf16 v[116:119], v[192:195], v[240:243], v[116:119]
  ds_read_b64_tr_b16 v[192:193], v20 offset:16384
  ds_read_b64_tr_b16 v[194:195], v20 offset:17408
  v_mfma_f32_16x16x32_bf16 v[88:91], v[196:199], v[144:147], v[88:91]
  v_mfma_f32_16x16x32_bf16 v[120:123], v[196:199], v[240:243], v[120:123]
  ds_read_b64_tr_b16 v[196:197], v21 offset:16384
  ds_read_b64_tr_b16 v[198:199], v21 offset:17408
  s_waitcnt lgkmcnt(12)
  v_mfma_f32_16x16x32_bf16 v[60:63], v[168:171], v[148:151], v[60:63]
  v_mfma_f32_16x16x32_bf16 v[92:95], v[168:171], v[244:247], v[92:95]
  ds_read_b64_tr_b16 v[168:169], v14 offset:24576
  ds_read_b64_tr_b16 v[170:171], v14 offset:25600
  v_mfma_f32_16x16x32_bf16 v[64:67], v[172:175], v[148:151], v[64:67]
  v_mfma_f32_16x16x32_bf16 v[96:99], v[172:175], v[244:247], v[96:99]
  ds_read_b64_tr_b16 v[172:173], v15 offset:24576
  ds_read_b64_tr_b16 v[174:175], v15 offset:25600
  s_waitcnt lgkmcnt(12)
  v_mfma_f32_16x16x32_bf16 v[68:71], v[176:179], v[148:151], v[68:71]
  v_mfma_f32_16x16x32_bf16 v[100:103], v[176:179], v[244:247], v[100:103]
  ds_read_b64_tr_b16 v[176:177], v16 offset:24576
  ds_read_b64_tr_b16 v[178:179], v16 offset:25600
  v_mfma_f32_16x16x32_bf16 v[72:75], v[180:183], v[148:151], v[72:75]
  v_mfma_f32_16x16x32_bf16 v[104:107], v[180:183], v[244:247], v[104:107]
  ds_read_b64_tr_b16 v[180:181], v17 offset:24576
  ds_read_b64_tr_b16 v[182:183], v17 offset:25600
  s_waitcnt lgkmcnt(12)
  v_mfma_f32_16x16x32_bf16 v[76:79], v[184:187], v[148:151], v[76:79]
  v_mfma_f32_16x16x32_bf16 v[108:111], v[184:187], v[244:247], v[108:111]
  ds_read_b64_tr_b16 v[184:185], v18 offset:24576
  ds_read_b64_tr_b16 v[186:187], v18 offset:25600
  v_mfma_f32_16x16x32_bf16 v[80:83], v[188:191], v[148:151], v[80:83]
  v_mfma_f32_16x16x32_bf16 v[112:115], v[188:191], v[244:247], v[112:115]
  ds_read_b64_tr_b16 v[188:189], v19 offset:24576
  ds_read_b64_tr_b16 v[190:191], v19 offset:25600
  s_waitcnt lgkmcnt(12)
  v_mfma_f32_16x16x32_bf16 v[84:87], v[192:195], v[148:151], v[84:87]
  v_mfma_f32_16x16x32_bf16 v[116:119], v[192:195], v[244:247], v[116:119]
  ds_read_b64_tr_b16 v[192:193], v20 offset:24576
  ds_read_b64_tr_b16 v[194:195], v20 offset:25600
  v_mfma_f32_16x16x32_bf16 v[88:91], v[196:199], v[148:151], v[88:91]
  v_mfma_f32_16x16x32_bf16 v[120:123], v[196:199], v[244:247], v[120:123]
  ds_read_b64_tr_b16 v[196:197], v21 offset:24576
  ds_read_b64_tr_b16 v[198:199], v21 offset:25600
  s_waitcnt lgkmcnt(12)
  v_mfma_f32_16x16x32_bf16 v[60:63], v[168:171], v[152:155], v[60:63]
  v_mfma_f32_16x16x32_bf16 v[92:95], v[168:171], v[248:251], v[92:95]
  v_mfma_f32_16x16x32_bf16 v[64:67], v[172:175], v[152:155], v[64:67]
  v_mfma_f32_16x16x32_bf16 v[96:99], v[172:175], v[248:251], v[96:99]
  s_waitcnt lgkmcnt(8)
  v_mfma_f32_16x16x32_bf16 v[68:71], v[176:179], v[152:155], v[68:71]
  v_mfma_f32_16x16x32_bf16 v[100:103], v[176:179], v[248:251], v[100:103]
  v_mfma_f32_16x16x32_bf16 v[72:75], v[180:183], v[152:155], v[72:75]
  v_mfma_f32_16x16x32_bf16 v[104:107], v[180:183], v[248:251], v[104:107]
  s_waitcnt lgkmcnt(4)
  v_mfma_f32_16x16x32_bf16 v[76:79], v[184:187], v[152:155], v[76:79]
  v_mfma_f32_16x16x32_bf16 v[108:111], v[184:187], v[248:251], v[108:111]
  v_mfma_f32_16x16x32_bf16 v[80:83], v[188:191], v[152:155], v[80:83]
  v_mfma_f32_16x16x32_bf16 v[112:115], v[188:191], v[248:251], v[112:115]
  s_waitcnt lgkmcnt(0)
  v_mfma_f32_16x16x32_bf16 v[84:87], v[192:195], v[152:155], v[84:87]
  v_mfma_f32_16x16x32_bf16 v[116:119], v[192:195], v[248:251], v[116:119]
  v_mfma_f32_16x16x32_bf16 v[88:91], v[196:199], v[152:155], v[88:91]
  v_mfma_f32_16x16x32_bf16 v[120:123], v[196:199], v[248:251], v[120:123]
  s_nop 7
  buffer_store_dwordx4 v[60:63], v4, s[20:23], 0 offen offset:0 sc1
  buffer_store_dwordx4 v[64:67], v4, s[20:23], 0 offen offset:1024 sc1
  buffer_store_dwordx4 v[68:71], v4, s[20:23], 0 offen offset:2048 sc1
  buffer_store_dwordx4 v[72:75], v4, s[20:23], 0 offen offset:3072 sc1
  buffer_store_dwordx4 v[76:79], v5, s[20:23], 0 offen offset:0 sc1
  buffer_store_dwordx4 v[80:83], v5, s[20:23], 0 offen offset:1024 sc1
  buffer_store_dwordx4 v[84:87], v5, s[20:23], 0 offen offset:2048 sc1
  buffer_store_dwordx4 v[88:91], v5, s[20:23], 0 offen offset:3072 sc1
  buffer_store_dwordx4 v[92:95], v4, s[20:23], s46 offen offset:0 sc1
  buffer_store_dwordx4 v[96:99], v4, s[20:23], s46 offen offset:1024 sc1
  buffer_store_dwordx4 v[100:103], v4, s[20:23], s46 offen offset:2048 sc1
  buffer_store_dwordx4 v[104:107], v4, s[20:23], s46 offen offset:3072 sc1
  buffer_store_dwordx4 v[108:111], v5, s[20:23], s46 offen offset:0 sc1
  buffer_store_dwordx4 v[112:115], v5, s[20:23], s46 offen offset:1024 sc1
  buffer_store_dwordx4 v[116:119], v5, s[20:23], s46 offen offset:2048 sc1
  buffer_store_dwordx4 v[120:123], v5, s[20:23], s46 offen offset:3072 sc1
  s_waitcnt vmcnt(0)
  s_barrier
  s_barrier
  s_mov_b32 s3, 0
  buffer_load_dwordx4 v[124:127], v4, s[24:27], s3 offen sc1
  s_mov_b32 s3, 2359296
  buffer_load_dwordx4 v[128:131], v4, s[24:27], s3 offen sc1
  s_mov_b32 s3, 4718592
  buffer_load_dwordx4 v[132:135], v4, s[24:27], s3 offen sc1
  s_mov_b32 s3, 7077888
  buffer_load_dwordx4 v[136:139], v4, s[24:27], s3 offen sc1
  s_mov_b32 s3, 9437184
  buffer_load_dwordx4 v[140:143], v4, s[24:27], s3 offen sc1
  s_mov_b32 s3, 11796480
  buffer_load_dwordx4 v[144:147], v4, s[24:27], s3 offen sc1
  s_mov_b32 s3, 14155776
  buffer_load_dwordx4 v[148:151], v4, s[24:27], s3 offen sc1
  s_mov_b32 s3, 16515072
  buffer_load_dwordx4 v[152:155], v4, s[24:27], s3 offen sc1
  s_mov_b32 s3, 8192
  buffer_load_dwordx4 v[156:159], v4, s[24:27], s3 offen sc1
  s_mov_b32 s3, 2367488
  buffer_load_dwordx4 v[160:163], v4, s[24:27], s3 offen sc1
  s_mov_b32 s3, 4726784
  buffer_load_dwordx4 v[164:167], v4, s[24:27], s3 offen sc1
  s_mov_b32 s3, 7086080
  buffer_load_dwordx4 v[168:171], v4, s[24:27], s3 offen sc1
  s_mov_b32 s3, 9445376
  buffer_load_dwordx4 v[172:175], v4, s[24:27], s3 offen sc1
  s_mov_b32 s3, 11804672
  buffer_load_dwordx4 v[176:179], v4, s[24:27], s3 offen sc1
  s_mov_b32 s3, 14163968
  buffer_load_dwordx4 v[180:183], v4, s[24:27], s3 offen sc1
  s_mov_b32 s3, 16523264
  buffer_load_dwordx4 v[184:187], v4, s[24:27], s3 offen sc1
  s_waitcnt vmcnt(14)
  v_add_f32 v124, v124, v128
  v_add_f32 v125, v125, v129
  v_add_f32 v126, v126, v130
  v_add_f32 v127, v127, v131
  s_waitcnt vmcnt(13)
  v_add_f32 v124, v124, v132
  v_add_f32 v125, v125, v133
  v_add_f32 v126, v126, v134
  v_add_f32 v127, v127, v135
  s_waitcnt vmcnt(12)
  v_add_f32 v124, v124, v136
  v_add_f32 v125, v125, v137
  v_add_f32 v126, v126, v138
  v_add_f32 v127, v127, v139
  s_waitcnt vmcnt(11)
  v_add_f32 v124, v124, v140
  v_add_f32 v125, v125, v141
  v_add_f32 v126, v126, v142
  v_add_f32 v127, v127, v143
  s_waitcnt vmcnt(10)
  v_add_f32 v124, v124, v144
  v_add_f32 v125, v125, v145
  v_add_f32 v126, v126, v146
  v_add_f32 v127, v127, v147
  s_waitcnt vmcnt(9)
  v_add_f32 v124, v124, v148
  v_add_f32 v125, v125, v149
  v_add_f32 v126, v126, v150
  v_add_f32 v127, v127, v151
  s_waitcnt vmcnt(8)
  v_add_f32 v124, v124, v152
  v_add_f32 v125, v125, v153
  v_add_f32 v126, v126, v154
  v_add_f32 v127, v127, v155
  v_cvt_pk_bf16_f32 v124, v124, v125
  v_cvt_pk_bf16_f32 v125, v126, v127
  buffer_store_dwordx2 v[124:125], v6, s[16:19], 0 offen
  s_waitcnt vmcnt(6)
  v_add_f32 v156, v156, v160
  v_add_f32 v157, v157, v161
  v_add_f32 v158, v158, v162
  v_add_f32 v159, v159, v163
  s_waitcnt vmcnt(5)
  v_add_f32 v156, v156, v164
  v_add_f32 v157, v157, v165
  v_add_f32 v158, v158, v166
  v_add_f32 v159, v159, v167
  s_waitcnt vmcnt(4)
  v_add_f32 v156, v156, v168
  v_add_f32 v157, v157, v169
  v_add_f32 v158, v158, v170
  v_add_f32 v159, v159, v171
  s_waitcnt vmcnt(3)
  v_add_f32 v156, v156, v172
  v_add_f32 v157, v157, v173
  v_add_f32 v158, v158, v174
  v_add_f32 v159, v159, v175
  s_waitcnt vmcnt(2)
  v_add_f32 v156, v156, v176
  v_add_f32 v157, v157, v177
  v_add_f32 v158, v158, v178
  v_add_f32 v159, v159, v179
  s_waitcnt vmcnt(1)
  v_add_f32 v156, v156, v180
  v_add_f32 v157, v157, v181
  v_add_f32 v158, v158, v182
  v_add_f32 v159, v159, v183
  s_waitcnt vmcnt(0)
  v_add_f32 v156, v156, v184
  v_add_f32 v157, v157, v185
  v_add_f32 v158, v158, v186
  v_add_f32 v159, v159, v187
  v_cvt_pk_bf16_f32 v156, v156, v157
  v_cvt_pk_bf16_f32 v157, v158, v159
  buffer_store_dwordx2 v[156:157], v7, s[16:19], 0 offen
  s_endpgm
L_slowc2a:
  v_mov_b32 v25, v24
  s_nop 1
  v_permlane32_swap_b32 v24, v25
  v_max_f32 v24, v24, v25
  v_mov_b32 v25, v24
  s_nop 1
  v_permlane16_swap_b32 v24, v25
  v_max_f32 v24, v24, v25
  v_max_f32 v24, s61, v24
  v_sub_f32 v25, 0, v24
  v_min_f32 v25, 0, v25
  v_exp_f32 v25, v25
  s_mov_b32 s60, 0x41000000
  s_mov_b32 s61, 0
  v_sub_f32 v232, v232, v24
  v_sub_f32 v233, v233, v24
  v_sub_f32 v234, v234, v24
  v_sub_f32 v235, v235, v24
  v_sub_f32 v124, v124, v24
  v_sub_f32 v125, v125, v24
  v_sub_f32 v126, v126, v24
  v_sub_f32 v127, v127, v24
  v_sub_f32 v128, v128, v24
  v_sub_f32 v129, v129, v24
  v_sub_f32 v130, v130, v24
  v_sub_f32 v131, v131, v24
  v_sub_f32 v132, v132, v24
  v_sub_f32 v133, v133, v24
  v_sub_f32 v134, v134, v24
  v_sub_f32 v135, v135, v24
  v_sub_f32 v136, v136, v24
  v_sub_f32 v137, v137, v24
  v_sub_f32 v138, v138, v24
  v_sub_f32 v139, v139, v24
  v_mul_f32 v60, v60, v25
  v_mul_f32 v61, v61, v25
  v_mul_f32 v62, v62, v25
  v_mul_f32 v63, v63, v25
  v_mul_f32 v64, v64, v25
  v_mul_f32 v65, v65, v25
  v_mul_f32 v66, v66, v25
  v_mul_f32 v67, v67, v25
  v_mul_f32 v68, v68, v25
  v_mul_f32 v69, v69, v25
  v_mul_f32 v70, v70, v25
  v_mul_f32 v71, v71, v25
  v_mul_f32 v72, v72, v25
  v_mul_f32 v73, v73, v25
  v_mul_f32 v74, v74, v25
  v_mul_f32 v75, v75, v25
  v_mul_f32 v76, v76, v25
  v_mul_f32 v77, v77, v25
  v_mul_f32 v78, v78, v25
  v_mul_f32 v79, v79, v25
  v_mul_f32 v80, v80, v25
  v_mul_f32 v81, v81, v25
  v_mul_f32 v82, v82, v25
  v_mul_f32 v83, v83, v25
  v_mul_f32 v84, v84, v25
  v_mul_f32 v85, v85, v25
  v_mul_f32 v86, v86, v25
  v_mul_f32 v87, v87, v25
  v_mul_f32 v88, v88, v25
  v_mul_f32 v89, v89, v25
  v_mul_f32 v90, v90, v25
  v_mul_f32 v91, v91, v25
  v_mul_f32 v160, v160, v25
  v_mul_f32 v161, v161, v25
  v_mul_f32 v162, v162, v25
  v_mul_f32 v163, v163, v25
  s_branch L_backc2a
L_slowc2b:
  v_mov_b32 v7, v6
  s_nop 1
  v_permlane32_swap_b32 v6, v7
  v_max_f32 v6, v6, v7
  v_mov_b32 v7, v6
  s_nop 1
  v_permlane16_swap_b32 v6, v7
  v_max_f32 v6, v6, v7
  v_max_f32 v6, s63, v6
  v_sub_f32 v7, 0, v6
  v_min_f32 v7, 0, v7
  v_exp_f32 v7, v7
  s_mov_b32 s62, 0x41000000
  s_mov_b32 s63, 0
  v_sub_f32 v236, v236, v6
  v_sub_f32 v237, v237, v6
  v_sub_f32 v238, v238, v6
  v_sub_f32 v239, v239, v6
  v_sub_f32 v140, v140, v6
  v_sub_f32 v141, v141, v6
  v_sub_f32 v142, v142, v6
  v_sub_f32 v143, v143, v6
  v_sub_f32 v144, v144, v6
  v_sub_f32 v145, v145, v6
  v_sub_f32 v146, v146, v6
  v_sub_f32 v147, v147, v6
  v_sub_f32 v148, v148, v6
  v_sub_f32 v149, v149, v6
  v_sub_f32 v150, v150, v6
  v_sub_f32 v151, v151, v6
  v_sub_f32 v152, v152, v6
  v_sub_f32 v153, v153, v6
  v_sub_f32 v154, v154, v6
  v_sub_f32 v155, v155, v6
  v_mul_f32 v92, v92, v7
  v_mul_f32 v93, v93, v7
  v_mul_f32 v94, v94, v7
  v_mul_f32 v95, v95, v7
  v_mul_f32 v96, v96, v7
  v_mul_f32 v97, v97, v7
  v_mul_f32 v98, v98, v7
  v_mul_f32 v99, v99, v7
  v_mul_f32 v100, v100, v7
  v_mul_f32 v101, v101, v7
  v_mul_f32 v102, v102, v7
  v_mul_f32 v103, v103, v7
  v_mul_f32 v104, v104, v7
  v_mul_f32 v105, v105, v7
  v_mul_f32 v106, v106, v7
  v_mul_f32 v107, v107, v7
  v_mul_f32 v108, v108, v7
  v_mul_f32 v109, v109, v7
  v_mul_f32 v110, v110, v7
  v_mul_f32 v111, v111, v7
  v_mul_f32 v112, v112, v7
  v_mul_f32 v113, v113, v7
  v_mul_f32 v114, v114, v7
  v_mul_f32 v115, v115, v7
  v_mul_f32 v116, v116, v7
  v_mul_f32 v117, v117, v7
  v_mul_f32 v118, v118, v7
  v_mul_f32 v119, v119, v7
  v_mul_f32 v120, v120, v7
  v_mul_f32 v121, v121, v7
  v_mul_f32 v122, v122, v7
  v_mul_f32 v123, v123, v7
  v_mul_f32 v164, v164, v7
  v_mul_f32 v165, v165, v7
  v_mul_f32 v166, v166, v7
  v_mul_f32 v167, v167, v7
  s_branch L_backc2b
L_c1:
  s_sub_u32 s49, s36, 4
  v_add_u32 v25, 128, v1
  v_lshlrev_b32 v25, 10, v25
  v_lshl_add_u32 v4, v2, 4, v25
  buffer_load_dwordx4 v[28:31], v4, s[28:31], 0 offen offset:0
  buffer_load_dwordx4 v[32:35], v4, s[28:31], 0 offen offset:64
  buffer_load_dwordx4 v[36:39], v4, s[28:31], 0 offen offset:128
  buffer_load_dwordx4 v[40:43], v4, s[28:31], 0 offen offset:192
  buffer_load_dwordx4 v[44:47], v4, s[28:31], 0 offen offset:256
  buffer_load_dwordx4 v[48:51], v4, s[28:31], 0 offen offset:320
  buffer_load_dwordx4 v[52:55], v4, s[28:31], 0 offen offset:384
  buffer_load_dwordx4 v[56:59], v4, s[28:31], 0 offen offset:448
  buffer_load_dwordx4 v[124:127], v4, s[28:31], 0 offen offset:512
  buffer_load_dwordx4 v[128:131], v4, s[28:31], 0 offen offset:576
  buffer_load_dwordx4 v[132:135], v4, s[28:31], 0 offen offset:640
  buffer_load_dwordx4 v[136:139], v4, s[28:31], 0 offen offset:704
  buffer_load_dwordx4 v[140:143], v4, s[28:31], 0 offen offset:768
  buffer_load_dwordx4 v[144:147], v4, s[28:31], 0 offen offset:832
  buffer_load_dwordx4 v[148:151], v4, s[28:31], 0 offen offset:896
  buffer_load_dwordx4 v[152:155], v4, s[28:31], 0 offen offset:960
  v_bfe_u32 v24, v0, 2, 2
  v_and_b32 v25, 3, v0
  v_and_b32 v26, 1, v2
  v_lshl_add_u32 v27, v2, 3, v24
  v_lshl_add_u32 v26, v26, 2, v24
  v_lshlrev_b32 v27, 8, v27
  v_lshrrev_b32 v3, 1, v25
  v_lshl_add_u32 v27, v3, 4, v27
  v_and_b32 v3, 1, v25
  v_lshl_add_u32 v27, v3, 3, v27
  v_xor_b32 v3, 0, v26
  v_lshl_add_u32 v14, v3, 5, v27
  v_xor_b32 v3, 1, v26
  v_lshl_add_u32 v15, v3, 5, v27
  v_xor_b32 v3, 2, v26
  v_lshl_add_u32 v16, v3, 5, v27
  v_xor_b32 v3, 3, v26
  v_lshl_add_u32 v17, v3, 5, v27
  v_xor_b32 v3, 4, v26
  v_lshl_add_u32 v18, v3, 5, v27
  v_xor_b32 v3, 5, v26
  v_lshl_add_u32 v19, v3, 5, v27
  v_xor_b32 v3, 6, v26
  v_lshl_add_u32 v20, v3, 5, v27
  v_xor_b32 v3, 7, v26
  v_lshl_add_u32 v21, v3, 5, v27
  v_mov_b32 v60, 0
  v_mov_b32 v61, 0
  v_mov_b32 v62, 0
  v_mov_b32 v63, 0
  v_mov_b32 v64, 0
  v_mov_b32 v65, 0
  v_mov_b32 v66, 0
  v_mov_b32 v67, 0
  v_mov_b32 v68, 0
  v_mov_b32 v69, 0
  v_mov_b32 v70, 0
  v_mov_b32 v71, 0
  v_mov_b32 v72, 0
  v_mov_b32 v73, 0
  v_mov_b32 v74, 0
  v_mov_b32 v75, 0
  v_mov_b32 v76, 0
  v_mov_b32 v77, 0
  v_mov_b32 v78, 0
  v_mov_b32 v79, 0
  v_mov_b32 v80, 0
  v_mov_b32 v81, 0
  v_mov_b32 v82, 0
  v_mov_b32 v83, 0
  v_mov_b32 v84, 0
  v_mov_b32 v85, 0
  v_mov_b32 v86, 0
  v_mov_b32 v87, 0
  v_mov_b32 v88, 0
  v_mov_b32 v89, 0
  v_mov_b32 v90, 0
  v_mov_b32 v91, 0
  s_barrier
  s_waitcnt vmcnt(0)
  ds_read_b64_tr_b16 v[168:169], v14 offset:0
  ds_read_b64_tr_b16 v[170:171], v14 offset:1024
  ds_read_b64_tr_b16 v[172:173], v15 offset:0
  ds_read_b64_tr_b16 v[174:175], v15 offset:1024
  ds_read_b64_tr_b16 v[176:177], v16 offset:0
  ds_read_b64_tr_b16 v[178:179], v16 offset:1024
  ds_read_b64_tr_b16 v[180:181], v17 offset:0
  ds_read_b64_tr_b16 v[182:183], v17 offset:1024
  ds_read_b64_tr_b16 v[184:185], v18 offset:0
  ds_read_b64_tr_b16 v[186:187], v18 offset:1024
  ds_read_b64_tr_b16 v[188:189], v19 offset:0
  ds_read_b64_tr_b16 v[190:191], v19 offset:1024
  ds_read_b64_tr_b16 v[192:193], v20 offset:0
  ds_read_b64_tr_b16 v[194:195], v20 offset:1024
  ds_read_b64_tr_b16 v[196:197], v21 offset:0
  ds_read_b64_tr_b16 v[198:199], v21 offset:1024
  s_waitcnt lgkmcnt(12)
  v_mfma_f32_16x16x32_bf16 v[60:63], v[168:171], v[28:31], v[60:63]
  ds_read_b64_tr_b16 v[168:169], v14 offset:8192
  ds_read_b64_tr_b16 v[170:171], v14 offset:9216
  v_mfma_f32_16x16x32_bf16 v[64:67], v[172:175], v[28:31], v[64:67]
  ds_read_b64_tr_b16 v[172:173], v15 offset:8192
  ds_read_b64_tr_b16 v[174:175], v15 offset:9216
  s_waitcnt lgkmcnt(12)
  v_mfma_f32_16x16x32_bf16 v[68:71], v[176:179], v[28:31], v[68:71]
  ds_read_b64_tr_b16 v[176:177], v16 offset:8192
  ds_read_b64_tr_b16 v[178:179], v16 offset:9216
  v_mfma_f32_16x16x32_bf16 v[72:75], v[180:183], v[28:31], v[72:75]
  ds_read_b64_tr_b16 v[180:181], v17 offset:8192
  ds_read_b64_tr_b16 v[182:183], v17 offset:9216
  s_waitcnt lgkmcnt(12)
  v_mfma_f32_16x16x32_bf16 v[76:79], v[184:187], v[28:31], v[76:79]
  ds_read_b64_tr_b16 v[184:185], v18 offset:8192
  ds_read_b64_tr_b16 v[186:187], v18 offset:9216
  v_mfma_f32_16x16x32_bf16 v[80:83], v[188:191], v[28:31], v[80:83]
  ds_read_b64_tr_b16 v[188:189], v19 offset:8192
  ds_read_b64_tr_b16 v[190:191], v19 offset:9216
  s_waitcnt lgkmcnt(12)
  v_mfma_f32_16x16x32_bf16 v[84:87], v[192:195], v[28:31], v[84:87]
  ds_read_b64_tr_b16 v[192:193], v20 offset:8192
  ds_read_b64_tr_b16 v[194:195], v20 offset:9216
  v_mfma_f32_16x16x32_bf16 v[88:91], v[196:199], v[28:31], v[88:91]
  ds_read_b64_tr_b16 v[196:197], v21 offset:8192
  ds_read_b64_tr_b16 v[198:199], v21 offset:9216
  s_waitcnt lgkmcnt(12)
  v_mfma_f32_16x16x32_bf16 v[60:63], v[168:171], v[32:35], v[60:63]
  v_mfma_f32_16x16x32_bf16 v[64:67], v[172:175], v[32:35], v[64:67]
  s_waitcnt lgkmcnt(8)
  v_mfma_f32_16x16x32_bf16 v[68:71], v[176:179], v[32:35], v[68:71]
  v_mfma_f32_16x16x32_bf16 v[72:75], v[180:183], v[32:35], v[72:75]
  s_waitcnt lgkmcnt(4)
  v_mfma_f32_16x16x32_bf16 v[76:79], v[184:187], v[32:35], v[76:79]
  v_mfma_f32_16x16x32_bf16 v[80:83], v[188:191], v[32:35], v[80:83]
  s_waitcnt lgkmcnt(0)
  v_mfma_f32_16x16x32_bf16 v[84:87], v[192:195], v[32:35], v[84:87]
  v_mfma_f32_16x16x32_bf16 v[88:91], v[196:199], v[32:35], v[88:91]
  s_barrier
  s_mov_b32 s3, 32768
  v_add_u32 v14, s3, v14
  v_add_u32 v15, s3, v15
  v_add_u32 v16, s3, v16
  v_add_u32 v17, s3, v17
  v_add_u32 v18, s3, v18
  v_add_u32 v19, s3, v19
  v_add_u32 v20, s3, v20
  v_add_u32 v21, s3, v21
  ds_read_b64_tr_b16 v[168:169], v14 offset:0
  ds_read_b64_tr_b16 v[170:171], v14 offset:1024
  ds_read_b64_tr_b16 v[172:173], v15 offset:0
  ds_read_b64_tr_b16 v[174:175], v15 offset:1024
  ds_read_b64_tr_b16 v[176:177], v16 offset:0
  ds_read_b64_tr_b16 v[178:179], v16 offset:1024
  ds_read_b64_tr_b16 v[180:181], v17 offset:0
  ds_read_b64_tr_b16 v[182:183], v17 offset:1024
  ds_read_b64_tr_b16 v[184:185], v18 offset:0
  ds_read_b64_tr_b16 v[186:187], v18 offset:1024
  ds_read_b64_tr_b16 v[188:189], v19 offset:0
  ds_read_b64_tr_b16 v[190:191], v19 offset:1024
  ds_read_b64_tr_b16 v[192:193], v20 offset:0
  ds_read_b64_tr_b16 v[194:195], v20 offset:1024
  ds_read_b64_tr_b16 v[196:197], v21 offset:0
  ds_read_b64_tr_b16 v[198:199], v21 offset:1024
  s_waitcnt lgkmcnt(12)
  v_mfma_f32_16x16x32_bf16 v[60:63], v[168:171], v[36:39], v[60:63]
  ds_read_b64_tr_b16 v[168:169], v14 offset:8192
  ds_read_b64_tr_b16 v[170:171], v14 offset:9216
  v_mfma_f32_16x16x32_bf16 v[64:67], v[172:175], v[36:39], v[64:67]
  ds_read_b64_tr_b16 v[172:173], v15 offset:8192
  ds_read_b64_tr_b16 v[174:175], v15 offset:9216
  s_waitcnt lgkmcnt(12)
  v_mfma_f32_16x16x32_bf16 v[68:71], v[176:179], v[36:39], v[68:71]
  ds_read_b64_tr_b16 v[176:177], v16 offset:8192
  ds_read_b64_tr_b16 v[178:179], v16 offset:9216
  v_mfma_f32_16x16x32_bf16 v[72:75], v[180:183], v[36:39], v[72:75]
  ds_read_b64_tr_b16 v[180:181], v17 offset:8192
  ds_read_b64_tr_b16 v[182:183], v17 offset:9216
  s_waitcnt lgkmcnt(12)
  v_mfma_f32_16x16x32_bf16 v[76:79], v[184:187], v[36:39], v[76:79]
  ds_read_b64_tr_b16 v[184:185], v18 offset:8192
  ds_read_b64_tr_b16 v[186:187], v18 offset:9216
  v_mfma_f32_16x16x32_bf16 v[80:83], v[188:191], v[36:39], v[80:83]
  ds_read_b64_tr_b16 v[188:189], v19 offset:8192
  ds_read_b64_tr_b16 v[190:191], v19 offset:9216
  s_waitcnt lgkmcnt(12)
  v_mfma_f32_16x16x32_bf16 v[84:87], v[192:195], v[36:39], v[84:87]
  ds_read_b64_tr_b16 v[192:193], v20 offset:8192
  ds_read_b64_tr_b16 v[194:195], v20 offset:9216
  v_mfma_f32_16x16x32_bf16 v[88:91], v[196:199], v[36:39], v[88:91]
  ds_read_b64_tr_b16 v[196:197], v21 offset:8192
  ds_read_b64_tr_b16 v[198:199], v21 offset:9216
  s_waitcnt lgkmcnt(12)
  v_mfma_f32_16x16x32_bf16 v[60:63], v[168:171], v[40:43], v[60:63]
  v_mfma_f32_16x16x32_bf16 v[64:67], v[172:175], v[40:43], v[64:67]
  s_waitcnt lgkmcnt(8)
  v_mfma_f32_16x16x32_bf16 v[68:71], v[176:179], v[40:43], v[68:71]
  v_mfma_f32_16x16x32_bf16 v[72:75], v[180:183], v[40:43], v[72:75]
  s_waitcnt lgkmcnt(4)
  v_mfma_f32_16x16x32_bf16 v[76:79], v[184:187], v[40:43], v[76:79]
  v_mfma_f32_16x16x32_bf16 v[80:83], v[188:191], v[40:43], v[80:83]
  s_waitcnt lgkmcnt(0)
  v_mfma_f32_16x16x32_bf16 v[84:87], v[192:195], v[40:43], v[84:87]
  v_mfma_f32_16x16x32_bf16 v[88:91], v[196:199], v[40:43], v[88:91]
  s_barrier
  s_mov_b32 s3, 32768
  v_add_u32 v14, s3, v14
  v_add_u32 v15, s3, v15
  v_add_u32 v16, s3, v16
  v_add_u32 v17, s3, v17
  v_add_u32 v18, s3, v18
  v_add_u32 v19, s3, v19
  v_add_u32 v20, s3, v20
  v_add_u32 v21, s3, v21
  ds_read_b64_tr_b16 v[168:169], v14 offset:0
  ds_read_b64_tr_b16 v[170:171], v14 offset:1024
  ds_read_b64_tr_b16 v[172:173], v15 offset:0
  ds_read_b64_tr_b16 v[174:175], v15 offset:1024
  ds_read_b64_tr_b16 v[176:177], v16 offset:0
  ds_read_b64_tr_b16 v[178:179], v16 offset:1024
  ds_read_b64_tr_b16 v[180:181], v17 offset:0
  ds_read_b64_tr_b16 v[182:183], v17 offset:1024
  ds_read_b64_tr_b16 v[184:185], v18 offset:0
  ds_read_b64_tr_b16 v[186:187], v18 offset:1024
  ds_read_b64_tr_b16 v[188:189], v19 offset:0
  ds_read_b64_tr_b16 v[190:191], v19 offset:1024
  ds_read_b64_tr_b16 v[192:193], v20 offset:0
  ds_read_b64_tr_b16 v[194:195], v20 offset:1024
  ds_read_b64_tr_b16 v[196:197], v21 offset:0
  ds_read_b64_tr_b16 v[198:199], v21 offset:1024
  s_waitcnt lgkmcnt(12)
  v_mfma_f32_16x16x32_bf16 v[60:63], v[168:171], v[44:47], v[60:63]
  ds_read_b64_tr_b16 v[168:169], v14 offset:8192
  ds_read_b64_tr_b16 v[170:171], v14 offset:9216
  v_mfma_f32_16x16x32_bf16 v[64:67], v[172:175], v[44:47], v[64:67]
  ds_read_b64_tr_b16 v[172:173], v15 offset:8192
  ds_read_b64_tr_b16 v[174:175], v15 offset:9216
  s_waitcnt lgkmcnt(12)
  v_mfma_f32_16x16x32_bf16 v[68:71], v[176:179], v[44:47], v[68:71]
  ds_read_b64_tr_b16 v[176:177], v16 offset:8192
  ds_read_b64_tr_b16 v[178:179], v16 offset:9216
  v_mfma_f32_16x16x32_bf16 v[72:75], v[180:183], v[44:47], v[72:75]
  ds_read_b64_tr_b16 v[180:181], v17 offset:8192
  ds_read_b64_tr_b16 v[182:183], v17 offset:9216
  s_waitcnt lgkmcnt(12)
  v_mfma_f32_16x16x32_bf16 v[76:79], v[184:187], v[44:47], v[76:79]
  ds_read_b64_tr_b16 v[184:185], v18 offset:8192
  ds_read_b64_tr_b16 v[186:187], v18 offset:9216
  v_mfma_f32_16x16x32_bf16 v[80:83], v[188:191], v[44:47], v[80:83]
  ds_read_b64_tr_b16 v[188:189], v19 offset:8192
  ds_read_b64_tr_b16 v[190:191], v19 offset:9216
  s_waitcnt lgkmcnt(12)
  v_mfma_f32_16x16x32_bf16 v[84:87], v[192:195], v[44:47], v[84:87]
  ds_read_b64_tr_b16 v[192:193], v20 offset:8192
  ds_read_b64_tr_b16 v[194:195], v20 offset:9216
  v_mfma_f32_16x16x32_bf16 v[88:91], v[196:199], v[44:47], v[88:91]
  ds_read_b64_tr_b16 v[196:197], v21 offset:8192
  ds_read_b64_tr_b16 v[198:199], v21 offset:9216
  s_waitcnt lgkmcnt(12)
  v_mfma_f32_16x16x32_bf16 v[60:63], v[168:171], v[48:51], v[60:63]
  v_mfma_f32_16x16x32_bf16 v[64:67], v[172:175], v[48:51], v[64:67]
  s_waitcnt lgkmcnt(8)
  v_mfma_f32_16x16x32_bf16 v[68:71], v[176:179], v[48:51], v[68:71]
  v_mfma_f32_16x16x32_bf16 v[72:75], v[180:183], v[48:51], v[72:75]
  s_waitcnt lgkmcnt(4)
  v_mfma_f32_16x16x32_bf16 v[76:79], v[184:187], v[48:51], v[76:79]
  v_mfma_f32_16x16x32_bf16 v[80:83], v[188:191], v[48:51], v[80:83]
  s_waitcnt lgkmcnt(0)
  v_mfma_f32_16x16x32_bf16 v[84:87], v[192:195], v[48:51], v[84:87]
  v_mfma_f32_16x16x32_bf16 v[88:91], v[196:199], v[48:51], v[88:91]
  s_barrier
  s_mov_b32 s3, 32768
  v_add_u32 v14, s3, v14
  v_add_u32 v15, s3, v15
  v_add_u32 v16, s3, v16
  v_add_u32 v17, s3, v17
  v_add_u32 v18, s3, v18
  v_add_u32 v19, s3, v19
  v_add_u32 v20, s3, v20
  v_add_u32 v21, s3, v21
  ds_read_b64_tr_b16 v[168:169], v14 offset:0
  ds_read_b64_tr_b16 v[170:171], v14 offset:1024
  ds_read_b64_tr_b16 v[172:173], v15 offset:0
  ds_read_b64_tr_b16 v[174:175], v15 offset:1024
  ds_read_b64_tr_b16 v[176:177], v16 offset:0
  ds_read_b64_tr_b16 v[178:179], v16 offset:1024
  ds_read_b64_tr_b16 v[180:181], v17 offset:0
  ds_read_b64_tr_b16 v[182:183], v17 offset:1024
  ds_read_b64_tr_b16 v[184:185], v18 offset:0
  ds_read_b64_tr_b16 v[186:187], v18 offset:1024
  ds_read_b64_tr_b16 v[188:189], v19 offset:0
  ds_read_b64_tr_b16 v[190:191], v19 offset:1024
  ds_read_b64_tr_b16 v[192:193], v20 offset:0
  ds_read_b64_tr_b16 v[194:195], v20 offset:1024
  ds_read_b64_tr_b16 v[196:197], v21 offset:0
  ds_read_b64_tr_b16 v[198:199], v21 offset:1024
  s_waitcnt lgkmcnt(12)
  v_mfma_f32_16x16x32_bf16 v[60:63], v[168:171], v[52:55], v[60:63]
  ds_read_b64_tr_b16 v[168:169], v14 offset:8192
  ds_read_b64_tr_b16 v[170:171], v14 offset:9216
  v_mfma_f32_16x16x32_bf16 v[64:67], v[172:175], v[52:55], v[64:67]
  ds_read_b64_tr_b16 v[172:173], v15 offset:8192
  ds_read_b64_tr_b16 v[174:175], v15 offset:9216
  s_waitcnt lgkmcnt(12)
  v_mfma_f32_16x16x32_bf16 v[68:71], v[176:179], v[52:55], v[68:71]
  ds_read_b64_tr_b16 v[176:177], v16 offset:8192
  ds_read_b64_tr_b16 v[178:179], v16 offset:9216
  v_mfma_f32_16x16x32_bf16 v[72:75], v[180:183], v[52:55], v[72:75]
  ds_read_b64_tr_b16 v[180:181], v17 offset:8192
  ds_read_b64_tr_b16 v[182:183], v17 offset:9216
  s_waitcnt lgkmcnt(12)
  v_mfma_f32_16x16x32_bf16 v[76:79], v[184:187], v[52:55], v[76:79]
  ds_read_b64_tr_b16 v[184:185], v18 offset:8192
  ds_read_b64_tr_b16 v[186:187], v18 offset:9216
  v_mfma_f32_16x16x32_bf16 v[80:83], v[188:191], v[52:55], v[80:83]
  ds_read_b64_tr_b16 v[188:189], v19 offset:8192
  ds_read_b64_tr_b16 v[190:191], v19 offset:9216
  s_waitcnt lgkmcnt(12)
  v_mfma_f32_16x16x32_bf16 v[84:87], v[192:195], v[52:55], v[84:87]
  ds_read_b64_tr_b16 v[192:193], v20 offset:8192
  ds_read_b64_tr_b16 v[194:195], v20 offset:9216
  v_mfma_f32_16x16x32_bf16 v[88:91], v[196:199], v[52:55], v[88:91]
  ds_read_b64_tr_b16 v[196:197], v21 offset:8192
  ds_read_b64_tr_b16 v[198:199], v21 offset:9216
  s_waitcnt lgkmcnt(12)
  v_mfma_f32_16x16x32_bf16 v[60:63], v[168:171], v[56:59], v[60:63]
  v_mfma_f32_16x16x32_bf16 v[64:67], v[172:175], v[56:59], v[64:67]
  s_waitcnt lgkmcnt(8)
  v_mfma_f32_16x16x32_bf16 v[68:71], v[176:179], v[56:59], v[68:71]
  v_mfma_f32_16x16x32_bf16 v[72:75], v[180:183], v[56:59], v[72:75]
  s_waitcnt lgkmcnt(4)
  v_mfma_f32_16x16x32_bf16 v[76:79], v[184:187], v[56:59], v[76:79]
  v_mfma_f32_16x16x32_bf16 v[80:83], v[188:191], v[56:59], v[80:83]
  s_waitcnt lgkmcnt(0)
  v_mfma_f32_16x16x32_bf16 v[84:87], v[192:195], v[56:59], v[84:87]
  v_mfma_f32_16x16x32_bf16 v[88:91], v[196:199], v[56:59], v[88:91]
  s_barrier
  s_mov_b32 s3, 4294868992
  v_add_u32 v14, s3, v14
  v_add_u32 v15, s3, v15
  v_add_u32 v16, s3, v16
  v_add_u32 v17, s3, v17
  v_add_u32 v18, s3, v18
  v_add_u32 v19, s3, v19
  v_add_u32 v20, s3, v20
  v_add_u32 v21, s3, v21
  ds_read_b64_tr_b16 v[168:169], v14 offset:0
  ds_read_b64_tr_b16 v[170:171], v14 offset:1024
  ds_read_b64_tr_b16 v[172:173], v15 offset:0
  ds_read_b64_tr_b16 v[174:175], v15 offset:1024
  ds_read_b64_tr_b16 v[176:177], v16 offset:0
  ds_read_b64_tr_b16 v[178:179], v16 offset:1024
  ds_read_b64_tr_b16 v[180:181], v17 offset:0
  ds_read_b64_tr_b16 v[182:183], v17 offset:1024
  ds_read_b64_tr_b16 v[184:185], v18 offset:0
  ds_read_b64_tr_b16 v[186:187], v18 offset:1024
  ds_read_b64_tr_b16 v[188:189], v19 offset:0
  ds_read_b64_tr_b16 v[190:191], v19 offset:1024
  ds_read_b64_tr_b16 v[192:193], v20 offset:0
  ds_read_b64_tr_b16 v[194:195], v20 offset:1024
  ds_read_b64_tr_b16 v[196:197], v21 offset:0
  ds_read_b64_tr_b16 v[198:199], v21 offset:1024
  s_waitcnt lgkmcnt(12)
  v_mfma_f32_16x16x32_bf16 v[60:63], v[168:171], v[124:127], v[60:63]
  ds_read_b64_tr_b16 v[168:169], v14 offset:8192
  ds_read_b64_tr_b16 v[170:171], v14 offset:9216
  v_mfma_f32_16x16x32_bf16 v[64:67], v[172:175], v[124:127], v[64:67]
  ds_read_b64_tr_b16 v[172:173], v15 offset:8192
  ds_read_b64_tr_b16 v[174:175], v15 offset:9216
  s_waitcnt lgkmcnt(12)
  v_mfma_f32_16x16x32_bf16 v[68:71], v[176:179], v[124:127], v[68:71]
  ds_read_b64_tr_b16 v[176:177], v16 offset:8192
  ds_read_b64_tr_b16 v[178:179], v16 offset:9216
  v_mfma_f32_16x16x32_bf16 v[72:75], v[180:183], v[124:127], v[72:75]
  ds_read_b64_tr_b16 v[180:181], v17 offset:8192
  ds_read_b64_tr_b16 v[182:183], v17 offset:9216
  s_waitcnt lgkmcnt(12)
  v_mfma_f32_16x16x32_bf16 v[76:79], v[184:187], v[124:127], v[76:79]
  ds_read_b64_tr_b16 v[184:185], v18 offset:8192
  ds_read_b64_tr_b16 v[186:187], v18 offset:9216
  v_mfma_f32_16x16x32_bf16 v[80:83], v[188:191], v[124:127], v[80:83]
  ds_read_b64_tr_b16 v[188:189], v19 offset:8192
  ds_read_b64_tr_b16 v[190:191], v19 offset:9216
  s_waitcnt lgkmcnt(12)
  v_mfma_f32_16x16x32_bf16 v[84:87], v[192:195], v[124:127], v[84:87]
  ds_read_b64_tr_b16 v[192:193], v20 offset:8192
  ds_read_b64_tr_b16 v[194:195], v20 offset:9216
  v_mfma_f32_16x16x32_bf16 v[88:91], v[196:199], v[124:127], v[88:91]
  ds_read_b64_tr_b16 v[196:197], v21 offset:8192
  ds_read_b64_tr_b16 v[198:199], v21 offset:9216
  s_waitcnt lgkmcnt(12)
  v_mfma_f32_16x16x32_bf16 v[60:63], v[168:171], v[128:131], v[60:63]
  v_mfma_f32_16x16x32_bf16 v[64:67], v[172:175], v[128:131], v[64:67]
  s_waitcnt lgkmcnt(8)
  v_mfma_f32_16x16x32_bf16 v[68:71], v[176:179], v[128:131], v[68:71]
  v_mfma_f32_16x16x32_bf16 v[72:75], v[180:183], v[128:131], v[72:75]
  s_waitcnt lgkmcnt(4)
  v_mfma_f32_16x16x32_bf16 v[76:79], v[184:187], v[128:131], v[76:79]
  v_mfma_f32_16x16x32_bf16 v[80:83], v[188:191], v[128:131], v[80:83]
  s_waitcnt lgkmcnt(0)
  v_mfma_f32_16x16x32_bf16 v[84:87], v[192:195], v[128:131], v[84:87]
  v_mfma_f32_16x16x32_bf16 v[88:91], v[196:199], v[128:131], v[88:91]
  s_barrier
  s_mov_b32 s3, 32768
  v_add_u32 v14, s3, v14
  v_add_u32 v15, s3, v15
  v_add_u32 v16, s3, v16
  v_add_u32 v17, s3, v17
  v_add_u32 v18, s3, v18
  v_add_u32 v19, s3, v19
  v_add_u32 v20, s3, v20
  v_add_u32 v21, s3, v21
  ds_read_b64_tr_b16 v[168:169], v14 offset:0
  ds_read_b64_tr_b16 v[170:171], v14 offset:1024
  ds_read_b64_tr_b16 v[172:173], v15 offset:0
  ds_read_b64_tr_b16 v[174:175], v15 offset:1024
  ds_read_b64_tr_b16 v[176:177], v16 offset:0
  ds_read_b64_tr_b16 v[178:179], v16 offset:1024
  ds_read_b64_tr_b16 v[180:181], v17 offset:0
  ds_read_b64_tr_b16 v[182:183], v17 offset:1024
  ds_read_b64_tr_b16 v[184:185], v18 offset:0
  ds_read_b64_tr_b16 v[186:187], v18 offset:1024
  ds_read_b64_tr_b16 v[188:189], v19 offset:0
  ds_read_b64_tr_b16 v[190:191], v19 offset:1024
  ds_read_b64_tr_b16 v[192:193], v20 offset:0
  ds_read_b64_tr_b16 v[194:195], v20 offset:1024
  ds_read_b64_tr_b16 v[196:197], v21 offset:0
  ds_read_b64_tr_b16 v[198:199], v21 offset:1024
  s_waitcnt lgkmcnt(12)
  v_mfma_f32_16x16x32_bf16 v[60:63], v[168:171], v[132:135], v[60:63]
  ds_read_b64_tr_b16 v[168:169], v14 offset:8192
  ds_read_b64_tr_b16 v[170:171], v14 offset:9216
  v_mfma_f32_16x16x32_bf16 v[64:67], v[172:175], v[132:135], v[64:67]
  ds_read_b64_tr_b16 v[172:173], v15 offset:8192
  ds_read_b64_tr_b16 v[174:175], v15 offset:9216
  s_waitcnt lgkmcnt(12)
  v_mfma_f32_16x16x32_bf16 v[68:71], v[176:179], v[132:135], v[68:71]
  ds_read_b64_tr_b16 v[176:177], v16 offset:8192
  ds_read_b64_tr_b16 v[178:179], v16 offset:9216
  v_mfma_f32_16x16x32_bf16 v[72:75], v[180:183], v[132:135], v[72:75]
  ds_read_b64_tr_b16 v[180:181], v17 offset:8192
  ds_read_b64_tr_b16 v[182:183], v17 offset:9216
  s_waitcnt lgkmcnt(12)
  v_mfma_f32_16x16x32_bf16 v[76:79], v[184:187], v[132:135], v[76:79]
  ds_read_b64_tr_b16 v[184:185], v18 offset:8192
  ds_read_b64_tr_b16 v[186:187], v18 offset:9216
  v_mfma_f32_16x16x32_bf16 v[80:83], v[188:191], v[132:135], v[80:83]
  ds_read_b64_tr_b16 v[188:189], v19 offset:8192
  ds_read_b64_tr_b16 v[190:191], v19 offset:9216
  s_waitcnt lgkmcnt(12)
  v_mfma_f32_16x16x32_bf16 v[84:87], v[192:195], v[132:135], v[84:87]
  ds_read_b64_tr_b16 v[192:193], v20 offset:8192
  ds_read_b64_tr_b16 v[194:195], v20 offset:9216
  v_mfma_f32_16x16x32_bf16 v[88:91], v[196:199], v[132:135], v[88:91]
  ds_read_b64_tr_b16 v[196:197], v21 offset:8192
  ds_read_b64_tr_b16 v[198:199], v21 offset:9216
  s_waitcnt lgkmcnt(12)
  v_mfma_f32_16x16x32_bf16 v[60:63], v[168:171], v[136:139], v[60:63]
  v_mfma_f32_16x16x32_bf16 v[64:67], v[172:175], v[136:139], v[64:67]
  s_waitcnt lgkmcnt(8)
  v_mfma_f32_16x16x32_bf16 v[68:71], v[176:179], v[136:139], v[68:71]
  v_mfma_f32_16x16x32_bf16 v[72:75], v[180:183], v[136:139], v[72:75]
  s_waitcnt lgkmcnt(4)
  v_mfma_f32_16x16x32_bf16 v[76:79], v[184:187], v[136:139], v[76:79]
  v_mfma_f32_16x16x32_bf16 v[80:83], v[188:191], v[136:139], v[80:83]
  s_waitcnt lgkmcnt(0)
  v_mfma_f32_16x16x32_bf16 v[84:87], v[192:195], v[136:139], v[84:87]
  v_mfma_f32_16x16x32_bf16 v[88:91], v[196:199], v[136:139], v[88:91]
  s_barrier
  s_mov_b32 s3, 32768
  v_add_u32 v14, s3, v14
  v_add_u32 v15, s3, v15
  v_add_u32 v16, s3, v16
  v_add_u32 v17, s3, v17
  v_add_u32 v18, s3, v18
  v_add_u32 v19, s3, v19
  v_add_u32 v20, s3, v20
  v_add_u32 v21, s3, v21
  ds_read_b64_tr_b16 v[168:169], v14 offset:0
  ds_read_b64_tr_b16 v[170:171], v14 offset:1024
  ds_read_b64_tr_b16 v[172:173], v15 offset:0
  ds_read_b64_tr_b16 v[174:175], v15 offset:1024
  ds_read_b64_tr_b16 v[176:177], v16 offset:0
  ds_read_b64_tr_b16 v[178:179], v16 offset:1024
  ds_read_b64_tr_b16 v[180:181], v17 offset:0
  ds_read_b64_tr_b16 v[182:183], v17 offset:1024
  ds_read_b64_tr_b16 v[184:185], v18 offset:0
  ds_read_b64_tr_b16 v[186:187], v18 offset:1024
  ds_read_b64_tr_b16 v[188:189], v19 offset:0
  ds_read_b64_tr_b16 v[190:191], v19 offset:1024
  ds_read_b64_tr_b16 v[192:193], v20 offset:0
  ds_read_b64_tr_b16 v[194:195], v20 offset:1024
  ds_read_b64_tr_b16 v[196:197], v21 offset:0
  ds_read_b64_tr_b16 v[198:199], v21 offset:1024
  s_waitcnt lgkmcnt(12)
  v_mfma_f32_16x16x32_bf16 v[60:63], v[168:171], v[140:143], v[60:63]
  ds_read_b64_tr_b16 v[168:169], v14 offset:8192
  ds_read_b64_tr_b16 v[170:171], v14 offset:9216
  v_mfma_f32_16x16x32_bf16 v[64:67], v[172:175], v[140:143], v[64:67]
  ds_read_b64_tr_b16 v[172:173], v15 offset:8192
  ds_read_b64_tr_b16 v[174:175], v15 offset:9216
  s_waitcnt lgkmcnt(12)
  v_mfma_f32_16x16x32_bf16 v[68:71], v[176:179], v[140:143], v[68:71]
  ds_read_b64_tr_b16 v[176:177], v16 offset:8192
  ds_read_b64_tr_b16 v[178:179], v16 offset:9216
  v_mfma_f32_16x16x32_bf16 v[72:75], v[180:183], v[140:143], v[72:75]
  ds_read_b64_tr_b16 v[180:181], v17 offset:8192
  ds_read_b64_tr_b16 v[182:183], v17 offset:9216
  s_waitcnt lgkmcnt(12)
  v_mfma_f32_16x16x32_bf16 v[76:79], v[184:187], v[140:143], v[76:79]
  ds_read_b64_tr_b16 v[184:185], v18 offset:8192
  ds_read_b64_tr_b16 v[186:187], v18 offset:9216
  v_mfma_f32_16x16x32_bf16 v[80:83], v[188:191], v[140:143], v[80:83]
  ds_read_b64_tr_b16 v[188:189], v19 offset:8192
  ds_read_b64_tr_b16 v[190:191], v19 offset:9216
  s_waitcnt lgkmcnt(12)
  v_mfma_f32_16x16x32_bf16 v[84:87], v[192:195], v[140:143], v[84:87]
  ds_read_b64_tr_b16 v[192:193], v20 offset:8192
  ds_read_b64_tr_b16 v[194:195], v20 offset:9216
  v_mfma_f32_16x16x32_bf16 v[88:91], v[196:199], v[140:143], v[88:91]
  ds_read_b64_tr_b16 v[196:197], v21 offset:8192
  ds_read_b64_tr_b16 v[198:199], v21 offset:9216
  s_waitcnt lgkmcnt(12)
  v_mfma_f32_16x16x32_bf16 v[60:63], v[168:171], v[144:147], v[60:63]
  v_mfma_f32_16x16x32_bf16 v[64:67], v[172:175], v[144:147], v[64:67]
  s_waitcnt lgkmcnt(8)
  v_mfma_f32_16x16x32_bf16 v[68:71], v[176:179], v[144:147], v[68:71]
  v_mfma_f32_16x16x32_bf16 v[72:75], v[180:183], v[144:147], v[72:75]
  s_waitcnt lgkmcnt(4)
  v_mfma_f32_16x16x32_bf16 v[76:79], v[184:187], v[144:147], v[76:79]
  v_mfma_f32_16x16x32_bf16 v[80:83], v[188:191], v[144:147], v[80:83]
  s_waitcnt lgkmcnt(0)
  v_mfma_f32_16x16x32_bf16 v[84:87], v[192:195], v[144:147], v[84:87]
  v_mfma_f32_16x16x32_bf16 v[88:91], v[196:199], v[144:147], v[88:91]
  s_barrier
  s_mov_b32 s3, 32768
  v_add_u32 v14, s3, v14
  v_add_u32 v15, s3, v15
  v_add_u32 v16, s3, v16
  v_add_u32 v17, s3, v17
  v_add_u32 v18, s3, v18
  v_add_u32 v19, s3, v19
  v_add_u32 v20, s3, v20
  v_add_u32 v21, s3, v21
  ds_read_b64_tr_b16 v[168:169], v14 offset:0
  ds_read_b64_tr_b16 v[170:171], v14 offset:1024
  ds_read_b64_tr_b16 v[172:173], v15 offset:0
  ds_read_b64_tr_b16 v[174:175], v15 offset:1024
  ds_read_b64_tr_b16 v[176:177], v16 offset:0
  ds_read_b64_tr_b16 v[178:179], v16 offset:1024
  ds_read_b64_tr_b16 v[180:181], v17 offset:0
  ds_read_b64_tr_b16 v[182:183], v17 offset:1024
  ds_read_b64_tr_b16 v[184:185], v18 offset:0
  ds_read_b64_tr_b16 v[186:187], v18 offset:1024
  ds_read_b64_tr_b16 v[188:189], v19 offset:0
  ds_read_b64_tr_b16 v[190:191], v19 offset:1024
  ds_read_b64_tr_b16 v[192:193], v20 offset:0
  ds_read_b64_tr_b16 v[194:195], v20 offset:1024
  ds_read_b64_tr_b16 v[196:197], v21 offset:0
  ds_read_b64_tr_b16 v[198:199], v21 offset:1024
  s_waitcnt lgkmcnt(12)
  v_mfma_f32_16x16x32_bf16 v[60:63], v[168:171], v[148:151], v[60:63]
  ds_read_b64_tr_b16 v[168:169], v14 offset:8192
  ds_read_b64_tr_b16 v[170:171], v14 offset:9216
  v_mfma_f32_16x16x32_bf16 v[64:67], v[172:175], v[148:151], v[64:67]
  ds_read_b64_tr_b16 v[172:173], v15 offset:8192
  ds_read_b64_tr_b16 v[174:175], v15 offset:9216
  s_waitcnt lgkmcnt(12)
  v_mfma_f32_16x16x32_bf16 v[68:71], v[176:179], v[148:151], v[68:71]
  ds_read_b64_tr_b16 v[176:177], v16 offset:8192
  ds_read_b64_tr_b16 v[178:179], v16 offset:9216
  v_mfma_f32_16x16x32_bf16 v[72:75], v[180:183], v[148:151], v[72:75]
  ds_read_b64_tr_b16 v[180:181], v17 offset:8192
  ds_read_b64_tr_b16 v[182:183], v17 offset:9216
  s_waitcnt lgkmcnt(12)
  v_mfma_f32_16x16x32_bf16 v[76:79], v[184:187], v[148:151], v[76:79]
  ds_read_b64_tr_b16 v[184:185], v18 offset:8192
  ds_read_b64_tr_b16 v[186:187], v18 offset:9216
  v_mfma_f32_16x16x32_bf16 v[80:83], v[188:191], v[148:151], v[80:83]
  ds_read_b64_tr_b16 v[188:189], v19 offset:8192
  ds_read_b64_tr_b16 v[190:191], v19 offset:9216
  s_waitcnt lgkmcnt(12)
  v_mfma_f32_16x16x32_bf16 v[84:87], v[192:195], v[148:151], v[84:87]
  ds_read_b64_tr_b16 v[192:193], v20 offset:8192
  ds_read_b64_tr_b16 v[194:195], v20 offset:9216
  v_mfma_f32_16x16x32_bf16 v[88:91], v[196:199], v[148:151], v[88:91]
  ds_read_b64_tr_b16 v[196:197], v21 offset:8192
  ds_read_b64_tr_b16 v[198:199], v21 offset:9216
  s_waitcnt lgkmcnt(12)
  v_mfma_f32_16x16x32_bf16 v[60:63], v[168:171], v[152:155], v[60:63]
  v_mfma_f32_16x16x32_bf16 v[64:67], v[172:175], v[152:155], v[64:67]
  s_waitcnt lgkmcnt(8)
  v_mfma_f32_16x16x32_bf16 v[68:71], v[176:179], v[152:155], v[68:71]
  v_mfma_f32_16x16x32_bf16 v[72:75], v[180:183], v[152:155], v[72:75]
  s_waitcnt lgkmcnt(4)
  v_mfma_f32_16x16x32_bf16 v[76:79], v[184:187], v[152:155], v[76:79]
  v_mfma_f32_16x16x32_bf16 v[80:83], v[188:191], v[152:155], v[80:83]
  s_waitcnt lgkmcnt(0)
  v_mfma_f32_16x16x32_bf16 v[84:87], v[192:195], v[152:155], v[84:87]
  v_mfma_f32_16x16x32_bf16 v[88:91], v[196:199], v[152:155], v[88:91]
  v_mul_u32_u24 v3, 1024, v2
  v_add_u32 v3, 4294934528, v3
  s_lshl_b32 s3, s49, 13
  v_subrev_u32 v3, s3, v3
  s_add_u32 s3, s3, 131072
  v_sub_u32 v14, v14, v3
  v_sub_u32 v15, v15, v3
  v_sub_u32 v16, v16, v3
  v_sub_u32 v17, v17, v3
  v_sub_u32 v18, v18, v3
  v_sub_u32 v19, v19, v3
  v_sub_u32 v20, v20, v3
  v_sub_u32 v21, v21, v3
  v_and_b32 v26, 1, v2
  v_lshrrev_b32 v27, 1, v2
  v_lshl_add_u32 v26, v26, 1, v27
  v_xor_b32 v26, v26, v1
  v_xor_b32 v3, 0, v26
  v_lshlrev_b32 v3, 4, v3
  v_lshl_add_u32 v10, v1, 8, v3
  v_add_u32 v10, s3, v10
  v_xor_b32 v3, 4, v26
  v_lshlrev_b32 v3, 4, v3
  v_lshl_add_u32 v11, v1, 8, v3
  v_add_u32 v11, s3, v11
  v_xor_b32 v3, 8, v26
  v_lshlrev_b32 v3, 4, v3
  v_lshl_add_u32 v12, v1, 8, v3
  v_add_u32 v12, s3, v12
  v_xor_b32 v3, 12, v26
  v_lshlrev_b32 v3, 4, v3
  v_lshl_add_u32 v13, v1, 8, v3
  v_add_u32 v13, s3, v13
  s_barrier
  ds_read_b128 v[168:171], v10 offset:0
  ds_read_b128 v[172:175], v11 offset:0
  ds_read_b128 v[176:179], v12 offset:0
  ds_read_b128 v[180:183], v13 offset:0
  ds_read_b128 v[184:187], v10 offset:4096
  ds_read_b128 v[188:191], v11 offset:4096
  ds_read_b128 v[192:195], v12 offset:4096
  ds_read_b128 v[196:199], v13 offset:4096
  v_mul_f32 v60, s44, v60
  v_mul_f32 v61, s44, v61
  v_mul_f32 v62, s44, v62
  v_mul_f32 v63, s44, v63
  v_mul_f32 v64, s44, v64
  v_mul_f32 v65, s44, v65
  v_mul_f32 v66, s44, v66
  v_mul_f32 v67, s44, v67
  v_mul_f32 v68, s44, v68
  v_mul_f32 v69, s44, v69
  v_mul_f32 v70, s44, v70
  v_mul_f32 v71, s44, v71
  v_mul_f32 v72, s44, v72
  v_mul_f32 v73, s44, v73
  v_mul_f32 v74, s44, v74
  v_mul_f32 v75, s44, v75
  v_mul_f32 v76, s44, v76
  v_mul_f32 v77, s44, v77
  v_mul_f32 v78, s44, v78
  v_mul_f32 v79, s44, v79
  v_mul_f32 v80, s44, v80
  v_mul_f32 v81, s44, v81
  v_mul_f32 v82, s44, v82
  v_mul_f32 v83, s44, v83
  v_mul_f32 v84, s44, v84
  v_mul_f32 v85, s44, v85
  v_mul_f32 v86, s44, v86
  v_mul_f32 v87, s44, v87
  v_mul_f32 v88, s44, v88
  v_mul_f32 v89, s44, v89
  v_mul_f32 v90, s44, v90
  v_mul_f32 v91, s44, v91
  v_cvt_pk_bf16_f32 v28, v60, v61
  v_cvt_pk_bf16_f32 v29, v62, v63
  v_cvt_pk_bf16_f32 v30, v64, v65
  v_cvt_pk_bf16_f32 v31, v66, v67
  v_cvt_pk_bf16_f32 v32, v68, v69
  v_cvt_pk_bf16_f32 v33, v70, v71
  v_cvt_pk_bf16_f32 v34, v72, v73
  v_cvt_pk_bf16_f32 v35, v74, v75
  v_cvt_pk_bf16_f32 v36, v76, v77
  v_cvt_pk_bf16_f32 v37, v78, v79
  v_cvt_pk_bf16_f32 v38, v80, v81
  v_cvt_pk_bf16_f32 v39, v82, v83
  v_cvt_pk_bf16_f32 v40, v84, v85
  v_cvt_pk_bf16_f32 v41, v86, v87
  v_cvt_pk_bf16_f32 v42, v88, v89
  v_cvt_pk_bf16_f32 v43, v90, v91
  v_mov_b32 v60, 0
  v_mov_b32 v61, 0
  v_mov_b32 v62, 0
  v_mov_b32 v63, 0
  v_mov_b32 v64, 0
  v_mov_b32 v65, 0
  v_mov_b32 v66, 0
  v_mov_b32 v67, 0
  v_mov_b32 v68, 0
  v_mov_b32 v69, 0
  v_mov_b32 v70, 0
  v_mov_b32 v71, 0
  v_mov_b32 v72, 0
  v_mov_b32 v73, 0
  v_mov_b32 v74, 0
  v_mov_b32 v75, 0
  v_mov_b32 v76, 0
  v_mov_b32 v77, 0
  v_mov_b32 v78, 0
  v_mov_b32 v79, 0
  v_mov_b32 v80, 0
  v_mov_b32 v81, 0
  v_mov_b32 v82, 0
  v_mov_b32 v83, 0
  v_mov_b32 v84, 0
  v_mov_b32 v85, 0
  v_mov_b32 v86, 0
  v_mov_b32 v87, 0
  v_mov_b32 v88, 0
  v_mov_b32 v89, 0
  v_mov_b32 v90, 0
  v_mov_b32 v91, 0
  v_permlane16_swap_b32 v28, v30
  v_permlane16_swap_b32 v29, v31
  v_permlane16_swap_b32 v32, v34
  v_permlane16_swap_b32 v33, v35
  v_permlane16_swap_b32 v36, v38
  v_permlane16_swap_b32 v37, v39
  v_permlane16_swap_b32 v40, v42
  v_permlane16_swap_b32 v41, v43
  v_mov_b32 v156, 0x3f803f80
  v_mov_b32 v157, 0x3f803f80
  v_mov_b32 v158, 0x3f803f80
  v_mov_b32 v159, 0x3f803f80
  v_mov_b32 v160, 0
  v_mov_b32 v161, 0
  v_mov_b32 v162, 0
  v_mov_b32 v163, 0
  v_mov_b32 v232, 0
  v_mov_b32 v233, 0
  v_mov_b32 v234, 0
  v_mov_b32 v235, 0
  s_mov_b32 s60, 0xff800000
  s_mov_b32 s61, 0xff800000
  s_mov_b32 s40, 0
  s_mov_b32 s41, 131072
L_loopc1:
  s_add_u32 s42, s41, 32768
  s_cmp_ge_u32 s42, 163840
  s_cselect_b32 s42, 0, s42
  s_sub_u32 s3, s42, s41
  s_waitcnt lgkmcnt(4)
  v_mfma_f32_16x16x32_bf16 v[124:127], v[168:171], v[28:31], v[232:235]
  ds_read_b64_tr_b16 v[168:169], v14 offset:16384
  ds_read_b64_tr_b16 v[170:171], v14 offset:20480
  v_mfma_f32_16x16x32_bf16 v[124:127], v[172:175], v[32:35], v[124:127]
  ds_read_b64_tr_b16 v[172:173], v15 offset:16384
  ds_read_b64_tr_b16 v[174:175], v15 offset:20480
  v_mfma_f32_16x16x32_bf16 v[124:127], v[176:179], v[36:39], v[124:127]
  ds_read_b64_tr_b16 v[176:177], v16 offset:16384
  ds_read_b64_tr_b16 v[178:179], v16 offset:20480
  v_mfma_f32_16x16x32_bf16 v[124:127], v[180:183], v[40:43], v[124:127]
  ds_read_b64_tr_b16 v[180:181], v17 offset:16384
  ds_read_b64_tr_b16 v[182:183], v17 offset:20480
  s_waitcnt lgkmcnt(8)
  v_mfma_f32_16x16x32_bf16 v[128:131], v[184:187], v[28:31], v[232:235]
  ds_read_b64_tr_b16 v[184:185], v18 offset:16384
  ds_read_b64_tr_b16 v[186:187], v18 offset:20480
  v_mfma_f32_16x16x32_bf16 v[128:131], v[188:191], v[32:35], v[128:131]
  ds_read_b64_tr_b16 v[188:189], v19 offset:16384
  ds_read_b64_tr_b16 v[190:191], v19 offset:20480
  v_mfma_f32_16x16x32_bf16 v[128:131], v[192:195], v[36:39], v[128:131]
  ds_read_b64_tr_b16 v[192:193], v20 offset:16384
  ds_read_b64_tr_b16 v[194:195], v20 offset:20480
  v_mfma_f32_16x16x32_bf16 v[128:131], v[196:199], v[40:43], v[128:131]
  ds_read_b64_tr_b16 v[196:197], v21 offset:16384
  ds_read_b64_tr_b16 v[198:199], v21 offset:20480
  v_add_u32 v10, s3, v10
  v_add_u32 v11, s3, v11
  v_add_u32 v12, s3, v12
  v_add_u32 v13, s3, v13
  s_nop 3
  v_max3_f32 v24, v124, v125, v126
  v_max3_f32 v25, v127, v128, v129
  v_max3_f32 v24, v24, v130, v131
  v_max_f32 v24, v24, v25
  v_cmp_lt_f32 vcc, s60, v24
  s_cbranch_vccnz L_slowc1a
L_backc1a:
  v_exp_f32 v124, v124
  v_exp_f32 v125, v125
  v_exp_f32 v126, v126
  v_exp_f32 v127, v127
  v_exp_f32 v128, v128
  v_exp_f32 v129, v129
  v_exp_f32 v130, v130
  v_exp_f32 v131, v131
  s_nop 0
  v_cvt_pk_bf16_f32 v124, v124, v125
  v_cvt_pk_bf16_f32 v125, v126, v127
  v_cvt_pk_bf16_f32 v126, v128, v129
  v_cvt_pk_bf16_f32 v127, v130, v131
  v_add_u32 v14, s3, v14
  v_add_u32 v15, s3, v15
  v_add_u32 v16, s3, v16
  v_add_u32 v17, s3, v17
  v_add_u32 v18, s3, v18
  v_add_u32 v19, s3, v19
  v_add_u32 v20, s3, v20
  v_add_u32 v21, s3, v21
  s_waitcnt lgkmcnt(0)
  s_barrier
  v_mfma_f32_16x16x32_bf16 v[160:163], v[156:159], v[124:127], v[160:163]
  v_mfma_f32_16x16x32_bf16 v[60:63], v[168:171], v[124:127], v[60:63]
  ds_read_b128 v[168:171], v10 offset:0
  v_mfma_f32_16x16x32_bf16 v[64:67], v[172:175], v[124:127], v[64:67]
  ds_read_b128 v[172:175], v11 offset:0
  v_mfma_f32_16x16x32_bf16 v[68:71], v[176:179], v[124:127], v[68:71]
  ds_read_b128 v[176:179], v12 offset:0
  v_mfma_f32_16x16x32_bf16 v[72:75], v[180:183], v[124:127], v[72:75]
  ds_read_b128 v[180:183], v13 offset:0
  v_mfma_f32_16x16x32_bf16 v[76:79], v[184:187], v[124:127], v[76:79]
  ds_read_b128 v[184:187], v10 offset:4096
  v_mfma_f32_16x16x32_bf16 v[80:83], v[188:191], v[124:127], v[80:83]
  ds_read_b128 v[188:191], v11 offset:4096
  v_mfma_f32_16x16x32_bf16 v[84:87], v[192:195], v[124:127], v[84:87]
  ds_read_b128 v[192:195], v12 offset:4096
  v_mfma_f32_16x16x32_bf16 v[88:91], v[196:199], v[124:127], v[88:91]
  ds_read_b128 v[196:199], v13 offset:4096
  s_mov_b32 s41, s42
  s_add_u32 s40, s40, 1
  s_cmp_lt_u32 s40, 16
  s_cbranch_scc1 L_loopc1
  v_lshlrev_b32 v4, 4, v0
  v_add_u32 v5, 4096, v4
  v_add_u32 v6, 131072, v4
  s_cmp_eq_u32 s49, 0
  s_cbranch_scc1 L_mrg_r
  s_nop 4
  ds_write_b128 v6, v[60:63] offset:0
  ds_write_b128 v6, v[64:67] offset:1024
  ds_write_b128 v6, v[68:71] offset:2048
  ds_write_b128 v6, v[72:75] offset:3072
  ds_write_b128 v6, v[76:79] offset:4096
  ds_write_b128 v6, v[80:83] offset:5120
  ds_write_b128 v6, v[84:87] offset:6144
  ds_write_b128 v6, v[88:91] offset:7168
  v_mov_b32 v161, v232
  ds_write_b64 v6, v[160:161] offset:8192
  s_waitcnt lgkmcnt(0)
  s_barrier
  s_barrier
  s_barrier
  s_barrier
  s_barrier
  s_endpgm
L_mrg_r:
  s_waitcnt lgkmcnt(0)
  s_barrier
  ds_read_b128 v[168:171], v6 offset:0
  ds_read_b128 v[172:175], v6 offset:1024
  ds_read_b128 v[176:179], v6 offset:2048
  ds_read_b128 v[180:183], v6 offset:3072
  ds_read_b128 v[184:187], v6 offset:4096
  ds_read_b128 v[188:191], v6 offset:5120
  ds_read_b128 v[192:195], v6 offset:6144
  ds_read_b128 v[196:199], v6 offset:7168
  ds_read_b64 v[24:25], v6 offset:8192
  s_waitcnt lgkmcnt(0)
  v_min_f32 v26, v25, v232
  v_sub_f32 v27, v26, v232
  v_sub_f32 v26, v26, v25
  v_exp_f32 v27, v27
  v_exp_f32 v26, v26
  s_nop 0
  v_mul_f32 v160, v160, v27
  v_fmac_f32 v160, v24, v26
  v_mul_f32 v60, v60, v27
  v_fmac_f32 v60, v168, v26
  v_mul_f32 v61, v61, v27
  v_fmac_f32 v61, v169, v26
  v_mul_f32 v62, v62, v27
  v_fmac_f32 v62, v170, v26
  v_mul_f32 v63, v63, v27
  v_fmac_f32 v63, v171, v26
  v_mul_f32 v64, v64, v27
  v_fmac_f32 v64, v172, v26
  v_mul_f32 v65, v65, v27
  v_fmac_f32 v65, v173, v26
  v_mul_f32 v66, v66, v27
  v_fmac_f32 v66, v174, v26
  v_mul_f32 v67, v67, v27
  v_fmac_f32 v67, v175, v26
  v_mul_f32 v68, v68, v27
  v_fmac_f32 v68, v176, v26
  v_mul_f32 v69, v69, v27
  v_fmac_f32 v69, v177, v26
  v_mul_f32 v70, v70, v27
  v_fmac_f32 v70, v178, v26
  v_mul_f32 v71, v71, v27
  v_fmac_f32 v71, v179, v26
  v_mul_f32 v72, v72, v27
  v_fmac_f32 v72, v180, v26
  v_mul_f32 v73, v73, v27
  v_fmac_f32 v73, v181, v26
  v_mul_f32 v74, v74, v27
  v_fmac_f32 v74, v182, v26
  v_mul_f32 v75, v75, v27
  v_fmac_f32 v75, v183, v26
  v_mul_f32 v76, v76, v27
  v_fmac_f32 v76, v184, v26
  v_mul_f32 v77, v77, v27
  v_fmac_f32 v77, v185, v26
  v_mul_f32 v78, v78, v27
  v_fmac_f32 v78, v186, v26
  v_mul_f32 v79, v79, v27
  v_fmac_f32 v79, v187, v26
  v_mul_f32 v80, v80, v27
  v_fmac_f32 v80, v188, v26
  v_mul_f32 v81, v81, v27
  v_fmac_f32 v81, v189, v26
  v_mul_f32 v82, v82, v27
  v_fmac_f32 v82, v190, v26
  v_mul_f32 v83, v83, v27
  v_fmac_f32 v83, v191, v26
  v_mul_f32 v84, v84, v27
  v_fmac_f32 v84, v192, v26
  v_mul_f32 v85, v85, v27
  v_fmac_f32 v85, v193, v26
  v_mul_f32 v86, v86, v27
  v_fmac_f32 v86, v194, v26
  v_mul_f32 v87, v87, v27
  v_fmac_f32 v87, v195, v26
  v_mul_f32 v88, v88, v27
  v_fmac_f32 v88, v196, v26
  v_mul_f32 v89, v89, v27
  v_fmac_f32 v89, v197, v26
  v_mul_f32 v90, v90, v27
  v_fmac_f32 v90, v198, v26
  v_mul_f32 v91, v91, v27
  v_fmac_f32 v91, v199, v26
  s_mov_b32 s45, 8
  s_mul_i32 s40, s37, 9
  s_add_u32 s40, s40, s45
  s_lshl_b32 s41, s40, 7
  s_lshl_b32 s39, s38, 2
  s_add_u32 s41, s41, s39
  s_lshl_b32 s41, s41, 10
  s_add_u32 s32, s12, s41
  s_addc_u32 s33, s13, 0
  s_mov_b32 s34, 4096
  s_mov_b32 s35, 0x00020000
  s_mov_b32 s46, 8192
  s_mov_b32 s47, 131072
  s_mov_b32 s48, 139264
  v_rcp_f32 v25, v160
  s_nop 0
  v_mul_f32 v60, v60, v25
  v_mul_f32 v61, v61, v25
  v_mul_f32 v62, v62, v25
  v_mul_f32 v63, v63, v25
  v_mul_f32 v64, v64, v25
  v_mul_f32 v65, v65, v25
  v_mul_f32 v66, v66, v25
  v_mul_f32 v67, v67, v25
  v_mul_f32 v68, v68, v25
  v_mul_f32 v69, v69, v25
  v_mul_f32 v70, v70, v25
  v_mul_f32 v71, v71, v25
  v_mul_f32 v72, v72, v25
  v_mul_f32 v73, v73, v25
  v_mul_f32 v74, v74, v25
  v_mul_f32 v75, v75, v25
  v_mul_f32 v76, v76, v25
  v_mul_f32 v77, v77, v25
  v_mul_f32 v78, v78, v25
  v_mul_f32 v79, v79, v25
  v_mul_f32 v80, v80, v25
  v_mul_f32 v81, v81, v25
  v_mul_f32 v82, v82, v25
  v_mul_f32 v83, v83, v25
  v_mul_f32 v84, v84, v25
  v_mul_f32 v85, v85, v25
  v_mul_f32 v86, v86, v25
  v_mul_f32 v87, v87, v25
  v_mul_f32 v88, v88, v25
  v_mul_f32 v89, v89, v25
  v_mul_f32 v90, v90, v25
  v_mul_f32 v91, v91, v25
  v_cvt_pk_bf16_f32 v28, v60, v61
  v_cvt_pk_bf16_f32 v29, v62, v63
  v_cvt_pk_bf16_f32 v30, v64, v65
  v_cvt_pk_bf16_f32 v31, v66, v67
  v_cvt_pk_bf16_f32 v32, v68, v69
  v_cvt_pk_bf16_f32 v33, v70, v71
  v_cvt_pk_bf16_f32 v34, v72, v73
  v_cvt_pk_bf16_f32 v35, v74, v75
  v_cvt_pk_bf16_f32 v36, v76, v77
  v_cvt_pk_bf16_f32 v37, v78, v79
  v_cvt_pk_bf16_f32 v38, v80, v81
  v_cvt_pk_bf16_f32 v39, v82, v83
  v_cvt_pk_bf16_f32 v40, v84, v85
  v_cvt_pk_bf16_f32 v41, v86, v87
  v_cvt_pk_bf16_f32 v42, v88, v89
  v_cvt_pk_bf16_f32 v43, v90, v91
  s_nop 1
  v_permlane16_swap_b32 v28, v30
  v_permlane16_swap_b32 v29, v31
  v_permlane16_swap_b32 v32, v34
  v_permlane16_swap_b32 v33, v35
  v_permlane16_swap_b32 v36, v38
  v_permlane16_swap_b32 v37, v39
  v_permlane16_swap_b32 v40, v42
  v_permlane16_swap_b32 v41, v43
  buffer_store_dwordx4 v[28:31], v4, s[32:35], 0 offen offset:0 sc1
  buffer_store_dwordx4 v[32:35], v4, s[32:35], 0 offen offset:1024 sc1
  buffer_store_dwordx4 v[36:39], v4, s[32:35], 0 offen offset:2048 sc1
  buffer_store_dwordx4 v[40:43], v4, s[32:35], 0 offen offset:3072 sc1
  s_lshr_b32 s42, s38, 2
  s_and_b32 s43, s38, 3
  s_lshl_b32 s41, s40, 7
  s_lshl_b32 s3, s42, 4
  s_add_u32 s41, s41, s3
  s_lshl_b32 s41, s41, 10
  s_add_u32 s28, s12, s41
  s_addc_u32 s29, s13, 0
  s_mov_b32 s30, 16384
  s_mov_b32 s31, 0x00020000
  v_bfe_u32 v24, v0, 2, 2
  v_and_b32 v25, 3, v0
  v_and_b32 v26, 1, v2
  v_lshl_add_u32 v27, v26, 4, v24
  v_lshrrev_b32 v3, 1, v2
  v_lshl_add_u32 v27, v3, 3, v27
  v_lshl_add_u32 v26, v26, 2, v24
  v_lshlrev_b32 v27, 8, v27
  v_lshrrev_b32 v3, 1, v25
  v_lshl_add_u32 v27, v3, 4, v27
  v_and_b32 v3, 1, v25
  v_lshl_add_u32 v27, v3, 3, v27
  v_xor_b32 v3, 0, v26
  v_lshl_add_u32 v14, v3, 5, v27
  v_xor_b32 v3, 1, v26
  v_lshl_add_u32 v15, v3, 5, v27
  v_xor_b32 v3, 2, v26
  v_lshl_add_u32 v16, v3, 5, v27
  v_xor_b32 v3, 3, v26
  v_lshl_add_u32 v17, v3, 5, v27
  v_xor_b32 v3, 4, v26
  v_lshl_add_u32 v18, v3, 5, v27
  v_xor_b32 v3, 5, v26
  v_lshl_add_u32 v19, v3, 5, v27
  v_xor_b32 v3, 6, v26
  v_lshl_add_u32 v20, v3, 5, v27
  v_xor_b32 v3, 7, v26
  v_lshl_add_u32 v21, v3, 5, v27
  s_lshl_b32 s3, s43, 15
  v_add_u32 v14, s3, v14
  v_add_u32 v15, s3, v15
  v_add_u32 v16, s3, v16
  v_add_u32 v17, s3, v17
  v_add_u32 v18, s3, v18
  v_add_u32 v19, s3, v19
  v_add_u32 v20, s3, v20
  v_add_u32 v21, s3, v21
  v_mov_b32 v60, 0
  v_mov_b32 v61, 0
  v_mov_b32 v62, 0
  v_mov_b32 v63, 0
  v_mov_b32 v64, 0
  v_mov_b32 v65, 0
  v_mov_b32 v66, 0
  v_mov_b32 v67, 0
  v_mov_b32 v68, 0
  v_mov_b32 v69, 0
  v_mov_b32 v70, 0
  v_mov_b32 v71, 0
  v_mov_b32 v72, 0
  v_mov_b32 v73, 0
  v_mov_b32 v74, 0
  v_mov_b32 v75, 0
  v_mov_b32 v76, 0
  v_mov_b32 v77, 0
  v_mov_b32 v78, 0
  v_mov_b32 v79, 0
  v_mov_b32 v80, 0
  v_mov_b32 v81, 0
  v_mov_b32 v82, 0
  v_mov_b32 v83, 0
  v_mov_b32 v84, 0
  v_mov_b32 v85, 0
  v_mov_b32 v86, 0
  v_mov_b32 v87, 0
  v_mov_b32 v88, 0
  v_mov_b32 v89, 0
  v_mov_b32 v90, 0
  v_mov_b32 v91, 0
  s_lshl_b32 s3, s37, 2
  s_add_u32 s3, s3, s43
  s_lshl_b32 s41, s42, 5
  s_add_u32 s41, s41, s3
  s_mul_i32 s41, s41, 9
  s_add_u32 s41, s41, s45
  s_lshl_b32 s41, s41, 13
  s_add_u32 s41, s41, 16777216
  s_add_u32 s20, s12, s41
  s_addc_u32 s21, s13, 0
  s_mov_b32 s22, 8192
  s_mov_b32 s23, 0x00020000
  s_mul_i32 s41, s3, 9
  s_add_u32 s41, s41, s45
  s_lshl_b32 s41, s41, 3
  s_add_u32 s41, s41, s42
  s_lshl_b32 s41, s41, 10
  s_add_u32 s41, s41, 16777216
  s_add_u32 s24, s12, s41
  s_addc_u32 s25, s13, 0
  s_mov_b32 s26, 16516096
  s_mov_b32 s27, 0x00020000
  s_mul_i32 s41, s37, 144
  s_lshl_b32 s39, s45, 4
  s_add_u32 s41, s41, s39
  s_lshl_b32 s41, s41, 10
  s_lshl_b32 s39, s43, 8
  s_add_u32 s41, s41, s39
  s_lshl_b32 s39, s42, 5
  s_add_u32 s41, s41, s39
  s_add_u32 s16, s74, s41
  s_addc_u32 s17, s75, 0
  s_sub_u32 s18, 1179648, s41
  s_mov_b32 s19, 0x00020000
  v_lshlrev_b32 v6, 10, v1
  v_lshl_add_u32 v6, v2, 3, v6
  v_add_u32 v7, 16384, v6
  s_waitcnt vmcnt(0)
  s_barrier
  ds_read_b64_tr_b16 v[168:169], v14 offset:0
  ds_read_b64_tr_b16 v[170:171], v14 offset:1024
  ds_read_b64_tr_b16 v[172:173], v15 offset:0
  ds_read_b64_tr_b16 v[174:175], v15 offset:1024
  ds_read_b64_tr_b16 v[176:177], v16 offset:0
  ds_read_b64_tr_b16 v[178:179], v16 offset:1024
  ds_read_b64_tr_b16 v[180:181], v17 offset:0
  ds_read_b64_tr_b16 v[182:183], v17 offset:1024
  ds_read_b64_tr_b16 v[184:185], v18 offset:0
  ds_read_b64_tr_b16 v[186:187], v18 offset:1024
  ds_read_b64_tr_b16 v[188:189], v19 offset:0
  ds_read_b64_tr_b16 v[190:191], v19 offset:1024
  ds_read_b64_tr_b16 v[192:193], v20 offset:0
  ds_read_b64_tr_b16 v[194:195], v20 offset:1024
  ds_read_b64_tr_b16 v[196:197], v21 offset:0
  ds_read_b64_tr_b16 v[198:199], v21 offset:1024
  s_waitcnt lgkmcnt(12)
  v_mfma_f32_16x16x32_bf16 v[60:63], v[168:171], v[28:31], v[60:63]
  ds_read_b64_tr_b16 v[168:169], v14 offset:8192
  ds_read_b64_tr_b16 v[170:171], v14 offset:9216
  v_mfma_f32_16x16x32_bf16 v[64:67], v[172:175], v[28:31], v[64:67]
  ds_read_b64_tr_b16 v[172:173], v15 offset:8192
  ds_read_b64_tr_b16 v[174:175], v15 offset:9216
  s_waitcnt lgkmcnt(12)
  v_mfma_f32_16x16x32_bf16 v[68:71], v[176:179], v[28:31], v[68:71]
  ds_read_b64_tr_b16 v[176:177], v16 offset:8192
  ds_read_b64_tr_b16 v[178:179], v16 offset:9216
  v_mfma_f32_16x16x32_bf16 v[72:75], v[180:183], v[28:31], v[72:75]
  ds_read_b64_tr_b16 v[180:181], v17 offset:8192
  ds_read_b64_tr_b16 v[182:183], v17 offset:9216
  s_waitcnt lgkmcnt(12)
  v_mfma_f32_16x16x32_bf16 v[76:79], v[184:187], v[28:31], v[76:79]
  ds_read_b64_tr_b16 v[184:185], v18 offset:8192
  ds_read_b64_tr_b16 v[186:187], v18 offset:9216
  v_mfma_f32_16x16x32_bf16 v[80:83], v[188:191], v[28:31], v[80:83]
  ds_read_b64_tr_b16 v[188:189], v19 offset:8192
  ds_read_b64_tr_b16 v[190:191], v19 offset:9216
  s_waitcnt lgkmcnt(12)
  v_mfma_f32_16x16x32_bf16 v[84:87], v[192:195], v[28:31], v[84:87]
  ds_read_b64_tr_b16 v[192:193], v20 offset:8192
  ds_read_b64_tr_b16 v[194:195], v20 offset:9216
  v_mfma_f32_16x16x32_bf16 v[88:91], v[196:199], v[28:31], v[88:91]
  ds_read_b64_tr_b16 v[196:197], v21 offset:8192
  ds_read_b64_tr_b16 v[198:199], v21 offset:9216
  s_waitcnt lgkmcnt(12)
  v_mfma_f32_16x16x32_bf16 v[60:63], v[168:171], v[32:35], v[60:63]
  ds_read_b64_tr_b16 v[168:169], v14 offset:16384
  ds_read_b64_tr_b16 v[170:171], v14 offset:17408
  v_mfma_f32_16x16x32_bf16 v[64:67], v[172:175], v[32:35], v[64:67]
  ds_read_b64_tr_b16 v[172:173], v15 offset:16384
  ds_read_b64_tr_b16 v[174:175], v15 offset:17408
  s_waitcnt lgkmcnt(12)
  v_mfma_f32_16x16x32_bf16 v[68:71], v[176:179], v[32:35], v[68:71]
  ds_read_b64_tr_b16 v[176:177], v16 offset:16384
  ds_read_b64_tr_b16 v[178:179], v16 offset:17408
  v_mfma_f32_16x16x32_bf16 v[72:75], v[180:183], v[32:35], v[72:75]
  ds_read_b64_tr_b16 v[180:181], v17 offset:16384
  ds_read_b64_tr_b16 v[182:183], v17 offset:17408
  s_waitcnt lgkmcnt(12)
  v_mfma_f32_16x16x32_bf16 v[76:79], v[184:187], v[32:35], v[76:79]
  ds_read_b64_tr_b16 v[184:185], v18 offset:16384
  ds_read_b64_tr_b16 v[186:187], v18 offset:17408
  v_mfma_f32_16x16x32_bf16 v[80:83], v[188:191], v[32:35], v[80:83]
  ds_read_b64_tr_b16 v[188:189], v19 offset:16384
  ds_read_b64_tr_b16 v[190:191], v19 offset:17408
  s_waitcnt lgkmcnt(12)
  v_mfma_f32_16x16x32_bf16 v[84:87], v[192:195], v[32:35], v[84:87]
  ds_read_b64_tr_b16 v[192:193], v20 offset:16384
  ds_read_b64_tr_b16 v[194:195], v20 offset:17408
  v_mfma_f32_16x16x32_bf16 v[88:91], v[196:199], v[32:35], v[88:91]
  ds_read_b64_tr_b16 v[196:197], v21 offset:16384
  ds_read_b64_tr_b16 v[198:199], v21 offset:17408
  s_waitcnt lgkmcnt(12)
  v_mfma_f32_16x16x32_bf16 v[60:63], v[168:171], v[36:39], v[60:63]
  ds_read_b64_tr_b16 v[168:169], v14 offset:24576
  ds_read_b64_tr_b16 v[170:171], v14 offset:25600
  v_mfma_f32_16x16x32_bf16 v[64:67], v[172:175], v[36:39], v[64:67]
  ds_read_b64_tr_b16 v[172:173], v15 offset:24576
  ds_read_b64_tr_b16 v[174:175], v15 offset:25600
  s_waitcnt lgkmcnt(12)
  v_mfma_f32_16x16x32_bf16 v[68:71], v[176:179], v[36:39], v[68:71]
  ds_read_b64_tr_b16 v[176:177], v16 offset:24576
  ds_read_b64_tr_b16 v[178:179], v16 offset:25600
  v_mfma_f32_16x16x32_bf16 v[72:75], v[180:183], v[36:39], v[72:75]
  ds_read_b64_tr_b16 v[180:181], v17 offset:24576
  ds_read_b64_tr_b16 v[182:183], v17 offset:25600
  s_waitcnt lgkmcnt(12)
  v_mfma_f32_16x16x32_bf16 v[76:79], v[184:187], v[36:39], v[76:79]
  ds_read_b64_tr_b16 v[184:185], v18 offset:24576
  ds_read_b64_tr_b16 v[186:187], v18 offset:25600
  v_mfma_f32_16x16x32_bf16 v[80:83], v[188:191], v[36:39], v[80:83]
  ds_read_b64_tr_b16 v[188:189], v19 offset:24576
  ds_read_b64_tr_b16 v[190:191], v19 offset:25600
  s_waitcnt lgkmcnt(12)
  v_mfma_f32_16x16x32_bf16 v[84:87], v[192:195], v[36:39], v[84:87]
  ds_read_b64_tr_b16 v[192:193], v20 offset:24576
  ds_read_b64_tr_b16 v[194:195], v20 offset:25600
  v_mfma_f32_16x16x32_bf16 v[88:91], v[196:199], v[36:39], v[88:91]
  ds_read_b64_tr_b16 v[196:197], v21 offset:24576
  ds_read_b64_tr_b16 v[198:199], v21 offset:25600
  s_waitcnt lgkmcnt(12)
  v_mfma_f32_16x16x32_bf16 v[60:63], v[168:171], v[40:43], v[60:63]
  v_mfma_f32_16x16x32_bf16 v[64:67], v[172:175], v[40:43], v[64:67]
  s_waitcnt lgkmcnt(8)
  v_mfma_f32_16x16x32_bf16 v[68:71], v[176:179], v[40:43], v[68:71]
  v_mfma_f32_16x16x32_bf16 v[72:75], v[180:183], v[40:43], v[72:75]
  s_waitcnt lgkmcnt(4)
  v_mfma_f32_16x16x32_bf16 v[76:79], v[184:187], v[40:43], v[76:79]
  v_mfma_f32_16x16x32_bf16 v[80:83], v[188:191], v[40:43], v[80:83]
  s_waitcnt lgkmcnt(0)
  v_mfma_f32_16x16x32_bf16 v[84:87], v[192:195], v[40:43], v[84:87]
  v_mfma_f32_16x16x32_bf16 v[88:91], v[196:199], v[40:43], v[88:91]
  s_barrier
  s_add_u32 s3, s43, 1
  s_and_b32 s3, s3, 3
  s_lshl_b32 s64, s3, 12
  s_add_u32 s68, s64, 131072
  s_add_u32 s3, s43, 2
  s_and_b32 s3, s3, 3
  s_lshl_b32 s65, s3, 12
  s_add_u32 s69, s65, 131072
  s_add_u32 s3, s43, 3
  s_and_b32 s3, s3, 3
  s_lshl_b32 s66, s3, 12
  s_add_u32 s70, s66, 131072
  buffer_load_dwordx4 v[44:47], v4, s[28:31], s64 offen offset:0 sc1
  buffer_load_dwordx4 v[48:51], v4, s[28:31], s64 offen offset:1024 sc1
  buffer_load_dwordx4 v[52:55], v4, s[28:31], s64 offen offset:2048 sc1
  buffer_load_dwordx4 v[56:59], v4, s[28:31], s64 offen offset:3072 sc1
  buffer_load_dwordx4 v[124:127], v4, s[28:31], s65 offen offset:0 sc1
  buffer_load_dwordx4 v[128:131], v4, s[28:31], s65 offen offset:1024 sc1
  buffer_load_dwordx4 v[132:135], v4, s[28:31], s65 offen offset:2048 sc1
  buffer_load_dwordx4 v[136:139], v4, s[28:31], s65 offen offset:3072 sc1
  buffer_load_dwordx4 v[140:143], v4, s[28:31], s66 offen offset:0 sc1
  buffer_load_dwordx4 v[144:147], v4, s[28:31], s66 offen offset:1024 sc1
  buffer_load_dwordx4 v[148:151], v4, s[28:31], s66 offen offset:2048 sc1
  buffer_load_dwordx4 v[152:155], v4, s[28:31], s66 offen offset:3072 sc1
  s_add_u32 s3, s43, 1
  s_and_b32 s3, s3, 3
  s_cmp_eq_u32 s3, 0
  s_mov_b32 s39, 0x8000
  s_cselect_b32 s3, 0xfffe8000, s39
  v_add_u32 v14, s3, v14
  v_add_u32 v15, s3, v15
  v_add_u32 v16, s3, v16
  v_add_u32 v17, s3, v17
  v_add_u32 v18, s3, v18
  v_add_u32 v19, s3, v19
  v_add_u32 v20, s3, v20
  v_add_u32 v21, s3, v21
  s_waitcnt vmcnt(8)
  ds_read_b64_tr_b16 v[168:169], v14 offset:0
  ds_read_b64_tr_b16 v[170:171], v14 offset:1024
  ds_read_b64_tr_b16 v[172:173], v15 offset:0
  ds_read_b64_tr_b16 v[174:175], v15 offset:1024
  ds_read_b64_tr_b16 v[176:177], v16 offset:0
  ds_read_b64_tr_b16 v[178:179], v16 offset:1024
  ds_read_b64_tr_b16 v[180:181], v17 offset:0
  ds_read_b64_tr_b16 v[182:183], v17 offset:1024
  ds_read_b64_tr_b16 v[184:185], v18 offset:0
  ds_read_b64_tr_b16 v[186:187], v18 offset:1024
  ds_read_b64_tr_b16 v[188:189], v19 offset:0
  ds_read_b64_tr_b16 v[190:191], v19 offset:1024
  ds_read_b64_tr_b16 v[192:193], v20 offset:0
  ds_read_b64_tr_b16 v[194:195], v20 offset:1024
  ds_read_b64_tr_b16 v[196:197], v21 offset:0
  ds_read_b64_tr_b16 v[198:199], v21 offset:1024
  s_waitcnt lgkmcnt(12)
  v_mfma_f32_16x16x32_bf16 v[60:63], v[168:171], v[44:47], v[60:63]
  ds_read_b64_tr_b16 v[168:169], v14 offset:8192
  ds_read_b64_tr_b16 v[170:171], v14 offset:9216
  v_mfma_f32_16x16x32_bf16 v[64:67], v[172:175], v[44:47], v[64:67]
  ds_read_b64_tr_b16 v[172:173], v15 offset:8192
  ds_read_b64_tr_b16 v[174:175], v15 offset:9216
  s_waitcnt lgkmcnt(12)
  v_mfma_f32_16x16x32_bf16 v[68:71], v[176:179], v[44:47], v[68:71]
  ds_read_b64_tr_b16 v[176:177], v16 offset:8192
  ds_read_b64_tr_b16 v[178:179], v16 offset:9216
  v_mfma_f32_16x16x32_bf16 v[72:75], v[180:183], v[44:47], v[72:75]
  ds_read_b64_tr_b16 v[180:181], v17 offset:8192
  ds_read_b64_tr_b16 v[182:183], v17 offset:9216
  s_waitcnt lgkmcnt(12)
  v_mfma_f32_16x16x32_bf16 v[76:79], v[184:187], v[44:47], v[76:79]
  ds_read_b64_tr_b16 v[184:185], v18 offset:8192
  ds_read_b64_tr_b16 v[186:187], v18 offset:9216
  v_mfma_f32_16x16x32_bf16 v[80:83], v[188:191], v[44:47], v[80:83]
  ds_read_b64_tr_b16 v[188:189], v19 offset:8192
  ds_read_b64_tr_b16 v[190:191], v19 offset:9216
  s_waitcnt lgkmcnt(12)
  v_mfma_f32_16x16x32_bf16 v[84:87], v[192:195], v[44:47], v[84:87]
  ds_read_b64_tr_b16 v[192:193], v20 offset:8192
  ds_read_b64_tr_b16 v[194:195], v20 offset:9216
  v_mfma_f32_16x16x32_bf16 v[88:91], v[196:199], v[44:47], v[88:91]
  ds_read_b64_tr_b16 v[196:197], v21 offset:8192
  ds_read_b64_tr_b16 v[198:199], v21 offset:9216
  s_waitcnt lgkmcnt(12)
  v_mfma_f32_16x16x32_bf16 v[60:63], v[168:171], v[48:51], v[60:63]
  ds_read_b64_tr_b16 v[168:169], v14 offset:16384
  ds_read_b64_tr_b16 v[170:171], v14 offset:17408
  v_mfma_f32_16x16x32_bf16 v[64:67], v[172:175], v[48:51], v[64:67]
  ds_read_b64_tr_b16 v[172:173], v15 offset:16384
  ds_read_b64_tr_b16 v[174:175], v15 offset:17408
  s_waitcnt lgkmcnt(12)
  v_mfma_f32_16x16x32_bf16 v[68:71], v[176:179], v[48:51], v[68:71]
  ds_read_b64_tr_b16 v[176:177], v16 offset:16384
  ds_read_b64_tr_b16 v[178:179], v16 offset:17408
  v_mfma_f32_16x16x32_bf16 v[72:75], v[180:183], v[48:51], v[72:75]
  ds_read_b64_tr_b16 v[180:181], v17 offset:16384
  ds_read_b64_tr_b16 v[182:183], v17 offset:17408
  s_waitcnt lgkmcnt(12)
  v_mfma_f32_16x16x32_bf16 v[76:79], v[184:187], v[48:51], v[76:79]
  ds_read_b64_tr_b16 v[184:185], v18 offset:16384
  ds_read_b64_tr_b16 v[186:187], v18 offset:17408
  v_mfma_f32_16x16x32_bf16 v[80:83], v[188:191], v[48:51], v[80:83]
  ds_read_b64_tr_b16 v[188:189], v19 offset:16384
  ds_read_b64_tr_b16 v[190:191], v19 offset:17408
  s_waitcnt lgkmcnt(12)
  v_mfma_f32_16x16x32_bf16 v[84:87], v[192:195], v[48:51], v[84:87]
  ds_read_b64_tr_b16 v[192:193], v20 offset:16384
  ds_read_b64_tr_b16 v[194:195], v20 offset:17408
  v_mfma_f32_16x16x32_bf16 v[88:91], v[196:199], v[48:51], v[88:91]
  ds_read_b64_tr_b16 v[196:197], v21 offset:16384
  ds_read_b64_tr_b16 v[198:199], v21 offset:17408
  s_waitcnt lgkmcnt(12)
  v_mfma_f32_16x16x32_bf16 v[60:63], v[168:171], v[52:55], v[60:63]
  ds_read_b64_tr_b16 v[168:169], v14 offset:24576
  ds_read_b64_tr_b16 v[170:171], v14 offset:25600
  v_mfma_f32_16x16x32_bf16 v[64:67], v[172:175], v[52:55], v[64:67]
  ds_read_b64_tr_b16 v[172:173], v15 offset:24576
  ds_read_b64_tr_b16 v[174:175], v15 offset:25600
  s_waitcnt lgkmcnt(12)
  v_mfma_f32_16x16x32_bf16 v[68:71], v[176:179], v[52:55], v[68:71]
  ds_read_b64_tr_b16 v[176:177], v16 offset:24576
  ds_read_b64_tr_b16 v[178:179], v16 offset:25600
  v_mfma_f32_16x16x32_bf16 v[72:75], v[180:183], v[52:55], v[72:75]
  ds_read_b64_tr_b16 v[180:181], v17 offset:24576
  ds_read_b64_tr_b16 v[182:183], v17 offset:25600
  s_waitcnt lgkmcnt(12)
  v_mfma_f32_16x16x32_bf16 v[76:79], v[184:187], v[52:55], v[76:79]
  ds_read_b64_tr_b16 v[184:185], v18 offset:24576
  ds_read_b64_tr_b16 v[186:187], v18 offset:25600
  v_mfma_f32_16x16x32_bf16 v[80:83], v[188:191], v[52:55], v[80:83]
  ds_read_b64_tr_b16 v[188:189], v19 offset:24576
  ds_read_b64_tr_b16 v[190:191], v19 offset:25600
  s_waitcnt lgkmcnt(12)
  v_mfma_f32_16x16x32_bf16 v[84:87], v[192:195], v[52:55], v[84:87]
  ds_read_b64_tr_b16 v[192:193], v20 offset:24576
  ds_read_b64_tr_b16 v[194:195], v20 offset:25600
  v_mfma_f32_16x16x32_bf16 v[88:91], v[196:199], v[52:55], v[88:91]
  ds_read_b64_tr_b16 v[196:197], v21 offset:24576
  ds_read_b64_tr_b16 v[198:199], v21 offset:25600
  s_waitcnt lgkmcnt(12)
  v_mfma_f32_16x16x32_bf16 v[60:63], v[168:171], v[56:59], v[60:63]
  v_mfma_f32_16x16x32_bf16 v[64:67], v[172:175], v[56:59], v[64:67]
  s_waitcnt lgkmcnt(8)
  v_mfma_f32_16x16x32_bf16 v[68:71], v[176:179], v[56:59], v[68:71]
  v_mfma_f32_16x16x32_bf16 v[72:75], v[180:183], v[56:59], v[72:75]
  s_waitcnt lgkmcnt(4)
  v_mfma_f32_16x16x32_bf16 v[76:79], v[184:187], v[56:59], v[76:79]
  v_mfma_f32_16x16x32_bf16 v[80:83], v[188:191], v[56:59], v[80:83]
  s_waitcnt lgkmcnt(0)
  v_mfma_f32_16x16x32_bf16 v[84:87], v[192:195], v[56:59], v[84:87]
  v_mfma_f32_16x16x32_bf16 v[88:91], v[196:199], v[56:59], v[88:91]
  s_add_u32 s3, s43, 2
  s_and_b32 s3, s3, 3
  s_cmp_eq_u32 s3, 0
  s_mov_b32 s39, 0x8000
  s_cselect_b32 s3, 0xfffe8000, s39
  v_add_u32 v14, s3, v14
  v_add_u32 v15, s3, v15
  v_add_u32 v16, s3, v16
  v_add_u32 v17, s3, v17
  v_add_u32 v18, s3, v18
  v_add_u32 v19, s3, v19
  v_add_u32 v20, s3, v20
  v_add_u32 v21, s3, v21
  s_waitcnt vmcnt(4)
  ds_read_b64_tr_b16 v[168:169], v14 offset:0
  ds_read_b64_tr_b16 v[170:171], v14 offset:1024
  ds_read_b64_tr_b16 v[172:173], v15 offset:0
  ds_read_b64_tr_b16 v[174:175], v15 offset:1024
  ds_read_b64_tr_b16 v[176:177], v16 offset:0
  ds_read_b64_tr_b16 v[178:179], v16 offset:1024
  ds_read_b64_tr_b16 v[180:181], v17 offset:0
  ds_read_b64_tr_b16 v[182:183], v17 offset:1024
  ds_read_b64_tr_b16 v[184:185], v18 offset:0
  ds_read_b64_tr_b16 v[186:187], v18 offset:1024
  ds_read_b64_tr_b16 v[188:189], v19 offset:0
  ds_read_b64_tr_b16 v[190:191], v19 offset:1024
  ds_read_b64_tr_b16 v[192:193], v20 offset:0
  ds_read_b64_tr_b16 v[194:195], v20 offset:1024
  ds_read_b64_tr_b16 v[196:197], v21 offset:0
  ds_read_b64_tr_b16 v[198:199], v21 offset:1024
  s_waitcnt lgkmcnt(12)
  v_mfma_f32_16x16x32_bf16 v[60:63], v[168:171], v[124:127], v[60:63]
  ds_read_b64_tr_b16 v[168:169], v14 offset:8192
  ds_read_b64_tr_b16 v[170:171], v14 offset:9216
  v_mfma_f32_16x16x32_bf16 v[64:67], v[172:175], v[124:127], v[64:67]
  ds_read_b64_tr_b16 v[172:173], v15 offset:8192
  ds_read_b64_tr_b16 v[174:175], v15 offset:9216
  s_waitcnt lgkmcnt(12)
  v_mfma_f32_16x16x32_bf16 v[68:71], v[176:179], v[124:127], v[68:71]
  ds_read_b64_tr_b16 v[176:177], v16 offset:8192
  ds_read_b64_tr_b16 v[178:179], v16 offset:9216
  v_mfma_f32_16x16x32_bf16 v[72:75], v[180:183], v[124:127], v[72:75]
  ds_read_b64_tr_b16 v[180:181], v17 offset:8192
  ds_read_b64_tr_b16 v[182:183], v17 offset:9216
  s_waitcnt lgkmcnt(12)
  v_mfma_f32_16x16x32_bf16 v[76:79], v[184:187], v[124:127], v[76:79]
  ds_read_b64_tr_b16 v[184:185], v18 offset:8192
  ds_read_b64_tr_b16 v[186:187], v18 offset:9216
  v_mfma_f32_16x16x32_bf16 v[80:83], v[188:191], v[124:127], v[80:83]
  ds_read_b64_tr_b16 v[188:189], v19 offset:8192
  ds_read_b64_tr_b16 v[190:191], v19 offset:9216
  s_waitcnt lgkmcnt(12)
  v_mfma_f32_16x16x32_bf16 v[84:87], v[192:195], v[124:127], v[84:87]
  ds_read_b64_tr_b16 v[192:193], v20 offset:8192
  ds_read_b64_tr_b16 v[194:195], v20 offset:9216
  v_mfma_f32_16x16x32_bf16 v[88:91], v[196:199], v[124:127], v[88:91]
  ds_read_b64_tr_b16 v[196:197], v21 offset:8192
  ds_read_b64_tr_b16 v[198:199], v21 offset:9216
  s_waitcnt lgkmcnt(12)
  v_mfma_f32_16x16x32_bf16 v[60:63], v[168:171], v[128:131], v[60:63]
  ds_read_b64_tr_b16 v[168:169], v14 offset:16384
  ds_read_b64_tr_b16 v[170:171], v14 offset:17408
  v_mfma_f32_16x16x32_bf16 v[64:67], v[172:175], v[128:131], v[64:67]
  ds_read_b64_tr_b16 v[172:173], v15 offset:16384
  ds_read_b64_tr_b16 v[174:175], v15 offset:17408
  s_waitcnt lgkmcnt(12)
  v_mfma_f32_16x16x32_bf16 v[68:71], v[176:179], v[128:131], v[68:71]
  ds_read_b64_tr_b16 v[176:177], v16 offset:16384
  ds_read_b64_tr_b16 v[178:179], v16 offset:17408
  v_mfma_f32_16x16x32_bf16 v[72:75], v[180:183], v[128:131], v[72:75]
  ds_read_b64_tr_b16 v[180:181], v17 offset:16384
  ds_read_b64_tr_b16 v[182:183], v17 offset:17408
  s_waitcnt lgkmcnt(12)
  v_mfma_f32_16x16x32_bf16 v[76:79], v[184:187], v[128:131], v[76:79]
  ds_read_b64_tr_b16 v[184:185], v18 offset:16384
  ds_read_b64_tr_b16 v[186:187], v18 offset:17408
  v_mfma_f32_16x16x32_bf16 v[80:83], v[188:191], v[128:131], v[80:83]
  ds_read_b64_tr_b16 v[188:189], v19 offset:16384
  ds_read_b64_tr_b16 v[190:191], v19 offset:17408
  s_waitcnt lgkmcnt(12)
  v_mfma_f32_16x16x32_bf16 v[84:87], v[192:195], v[128:131], v[84:87]
  ds_read_b64_tr_b16 v[192:193], v20 offset:16384
  ds_read_b64_tr_b16 v[194:195], v20 offset:17408
  v_mfma_f32_16x16x32_bf16 v[88:91], v[196:199], v[128:131], v[88:91]
  ds_read_b64_tr_b16 v[196:197], v21 offset:16384
  ds_read_b64_tr_b16 v[198:199], v21 offset:17408
  s_waitcnt lgkmcnt(12)
  v_mfma_f32_16x16x32_bf16 v[60:63], v[168:171], v[132:135], v[60:63]
  ds_read_b64_tr_b16 v[168:169], v14 offset:24576
  ds_read_b64_tr_b16 v[170:171], v14 offset:25600
  v_mfma_f32_16x16x32_bf16 v[64:67], v[172:175], v[132:135], v[64:67]
  ds_read_b64_tr_b16 v[172:173], v15 offset:24576
  ds_read_b64_tr_b16 v[174:175], v15 offset:25600
  s_waitcnt lgkmcnt(12)
  v_mfma_f32_16x16x32_bf16 v[68:71], v[176:179], v[132:135], v[68:71]
  ds_read_b64_tr_b16 v[176:177], v16 offset:24576
  ds_read_b64_tr_b16 v[178:179], v16 offset:25600
  v_mfma_f32_16x16x32_bf16 v[72:75], v[180:183], v[132:135], v[72:75]
  ds_read_b64_tr_b16 v[180:181], v17 offset:24576
  ds_read_b64_tr_b16 v[182:183], v17 offset:25600
  s_waitcnt lgkmcnt(12)
  v_mfma_f32_16x16x32_bf16 v[76:79], v[184:187], v[132:135], v[76:79]
  ds_read_b64_tr_b16 v[184:185], v18 offset:24576
  ds_read_b64_tr_b16 v[186:187], v18 offset:25600
  v_mfma_f32_16x16x32_bf16 v[80:83], v[188:191], v[132:135], v[80:83]
  ds_read_b64_tr_b16 v[188:189], v19 offset:24576
  ds_read_b64_tr_b16 v[190:191], v19 offset:25600
  s_waitcnt lgkmcnt(12)
  v_mfma_f32_16x16x32_bf16 v[84:87], v[192:195], v[132:135], v[84:87]
  ds_read_b64_tr_b16 v[192:193], v20 offset:24576
  ds_read_b64_tr_b16 v[194:195], v20 offset:25600
  v_mfma_f32_16x16x32_bf16 v[88:91], v[196:199], v[132:135], v[88:91]
  ds_read_b64_tr_b16 v[196:197], v21 offset:24576
  ds_read_b64_tr_b16 v[198:199], v21 offset:25600
  s_waitcnt lgkmcnt(12)
  v_mfma_f32_16x16x32_bf16 v[60:63], v[168:171], v[136:139], v[60:63]
  v_mfma_f32_16x16x32_bf16 v[64:67], v[172:175], v[136:139], v[64:67]
  s_waitcnt lgkmcnt(8)
  v_mfma_f32_16x16x32_bf16 v[68:71], v[176:179], v[136:139], v[68:71]
  v_mfma_f32_16x16x32_bf16 v[72:75], v[180:183], v[136:139], v[72:75]
  s_waitcnt lgkmcnt(4)
  v_mfma_f32_16x16x32_bf16 v[76:79], v[184:187], v[136:139], v[76:79]
  v_mfma_f32_16x16x32_bf16 v[80:83], v[188:191], v[136:139], v[80:83]
  s_waitcnt lgkmcnt(0)
  v_mfma_f32_16x16x32_bf16 v[84:87], v[192:195], v[136:139], v[84:87]
  v_mfma_f32_16x16x32_bf16 v[88:91], v[196:199], v[136:139], v[88:91]
  s_add_u32 s3, s43, 3
  s_and_b32 s3, s3, 3
  s_cmp_eq_u32 s3, 0
  s_mov_b32 s39, 0x8000
  s_cselect_b32 s3, 0xfffe8000, s39
  v_add_u32 v14, s3, v14
  v_add_u32 v15, s3, v15
  v_add_u32 v16, s3, v16
  v_add_u32 v17, s3, v17
  v_add_u32 v18, s3, v18
  v_add_u32 v19, s3, v19
  v_add_u32 v20, s3, v20
  v_add_u32 v21, s3, v21
  s_waitcnt vmcnt(0)
  ds_read_b64_tr_b16 v[168:169], v14 offset:0
  ds_read_b64_tr_b16 v[170:171], v14 offset:1024
  ds_read_b64_tr_b16 v[172:173], v15 offset:0
  ds_read_b64_tr_b16 v[174:175], v15 offset:1024
  ds_read_b64_tr_b16 v[176:177], v16 offset:0
  ds_read_b64_tr_b16 v[178:179], v16 offset:1024
  ds_read_b64_tr_b16 v[180:181], v17 offset:0
  ds_read_b64_tr_b16 v[182:183], v17 offset:1024
  ds_read_b64_tr_b16 v[184:185], v18 offset:0
  ds_read_b64_tr_b16 v[186:187], v18 offset:1024
  ds_read_b64_tr_b16 v[188:189], v19 offset:0
  ds_read_b64_tr_b16 v[190:191], v19 offset:1024
  ds_read_b64_tr_b16 v[192:193], v20 offset:0
  ds_read_b64_tr_b16 v[194:195], v20 offset:1024
  ds_read_b64_tr_b16 v[196:197], v21 offset:0
  ds_read_b64_tr_b16 v[198:199], v21 offset:1024
  s_waitcnt lgkmcnt(12)
  v_mfma_f32_16x16x32_bf16 v[60:63], v[168:171], v[140:143], v[60:63]
  ds_read_b64_tr_b16 v[168:169], v14 offset:8192
  ds_read_b64_tr_b16 v[170:171], v14 offset:9216
  v_mfma_f32_16x16x32_bf16 v[64:67], v[172:175], v[140:143], v[64:67]
  ds_read_b64_tr_b16 v[172:173], v15 offset:8192
  ds_read_b64_tr_b16 v[174:175], v15 offset:9216
  s_waitcnt lgkmcnt(12)
  v_mfma_f32_16x16x32_bf16 v[68:71], v[176:179], v[140:143], v[68:71]
  ds_read_b64_tr_b16 v[176:177], v16 offset:8192
  ds_read_b64_tr_b16 v[178:179], v16 offset:9216
  v_mfma_f32_16x16x32_bf16 v[72:75], v[180:183], v[140:143], v[72:75]
  ds_read_b64_tr_b16 v[180:181], v17 offset:8192
  ds_read_b64_tr_b16 v[182:183], v17 offset:9216
  s_waitcnt lgkmcnt(12)
  v_mfma_f32_16x16x32_bf16 v[76:79], v[184:187], v[140:143], v[76:79]
  ds_read_b64_tr_b16 v[184:185], v18 offset:8192
  ds_read_b64_tr_b16 v[186:187], v18 offset:9216
  v_mfma_f32_16x16x32_bf16 v[80:83], v[188:191], v[140:143], v[80:83]
  ds_read_b64_tr_b16 v[188:189], v19 offset:8192
  ds_read_b64_tr_b16 v[190:191], v19 offset:9216
  s_waitcnt lgkmcnt(12)
  v_mfma_f32_16x16x32_bf16 v[84:87], v[192:195], v[140:143], v[84:87]
  ds_read_b64_tr_b16 v[192:193], v20 offset:8192
  ds_read_b64_tr_b16 v[194:195], v20 offset:9216
  v_mfma_f32_16x16x32_bf16 v[88:91], v[196:199], v[140:143], v[88:91]
  ds_read_b64_tr_b16 v[196:197], v21 offset:8192
  ds_read_b64_tr_b16 v[198:199], v21 offset:9216
  s_waitcnt lgkmcnt(12)
  v_mfma_f32_16x16x32_bf16 v[60:63], v[168:171], v[144:147], v[60:63]
  ds_read_b64_tr_b16 v[168:169], v14 offset:16384
  ds_read_b64_tr_b16 v[170:171], v14 offset:17408
  v_mfma_f32_16x16x32_bf16 v[64:67], v[172:175], v[144:147], v[64:67]
  ds_read_b64_tr_b16 v[172:173], v15 offset:16384
  ds_read_b64_tr_b16 v[174:175], v15 offset:17408
  s_waitcnt lgkmcnt(12)
  v_mfma_f32_16x16x32_bf16 v[68:71], v[176:179], v[144:147], v[68:71]
  ds_read_b64_tr_b16 v[176:177], v16 offset:16384
  ds_read_b64_tr_b16 v[178:179], v16 offset:17408
  v_mfma_f32_16x16x32_bf16 v[72:75], v[180:183], v[144:147], v[72:75]
  ds_read_b64_tr_b16 v[180:181], v17 offset:16384
  ds_read_b64_tr_b16 v[182:183], v17 offset:17408
  s_waitcnt lgkmcnt(12)
  v_mfma_f32_16x16x32_bf16 v[76:79], v[184:187], v[144:147], v[76:79]
  ds_read_b64_tr_b16 v[184:185], v18 offset:16384
  ds_read_b64_tr_b16 v[186:187], v18 offset:17408
  v_mfma_f32_16x16x32_bf16 v[80:83], v[188:191], v[144:147], v[80:83]
  ds_read_b64_tr_b16 v[188:189], v19 offset:16384
  ds_read_b64_tr_b16 v[190:191], v19 offset:17408
  s_waitcnt lgkmcnt(12)
  v_mfma_f32_16x16x32_bf16 v[84:87], v[192:195], v[144:147], v[84:87]
  ds_read_b64_tr_b16 v[192:193], v20 offset:16384
  ds_read_b64_tr_b16 v[194:195], v20 offset:17408
  v_mfma_f32_16x16x32_bf16 v[88:91], v[196:199], v[144:147], v[88:91]
  ds_read_b64_tr_b16 v[196:197], v21 offset:16384
  ds_read_b64_tr_b16 v[198:199], v21 offset:17408
  s_waitcnt lgkmcnt(12)
  v_mfma_f32_16x16x32_bf16 v[60:63], v[168:171], v[148:151], v[60:63]
  ds_read_b64_tr_b16 v[168:169], v14 offset:24576
  ds_read_b64_tr_b16 v[170:171], v14 offset:25600
  v_mfma_f32_16x16x32_bf16 v[64:67], v[172:175], v[148:151], v[64:67]
  ds_read_b64_tr_b16 v[172:173], v15 offset:24576
  ds_read_b64_tr_b16 v[174:175], v15 offset:25600
  s_waitcnt lgkmcnt(12)
  v_mfma_f32_16x16x32_bf16 v[68:71], v[176:179], v[148:151], v[68:71]
  ds_read_b64_tr_b16 v[176:177], v16 offset:24576
  ds_read_b64_tr_b16 v[178:179], v16 offset:25600
  v_mfma_f32_16x16x32_bf16 v[72:75], v[180:183], v[148:151], v[72:75]
  ds_read_b64_tr_b16 v[180:181], v17 offset:24576
  ds_read_b64_tr_b16 v[182:183], v17 offset:25600
  s_waitcnt lgkmcnt(12)
  v_mfma_f32_16x16x32_bf16 v[76:79], v[184:187], v[148:151], v[76:79]
  ds_read_b64_tr_b16 v[184:185], v18 offset:24576
  ds_read_b64_tr_b16 v[186:187], v18 offset:25600
  v_mfma_f32_16x16x32_bf16 v[80:83], v[188:191], v[148:151], v[80:83]
  ds_read_b64_tr_b16 v[188:189], v19 offset:24576
  ds_read_b64_tr_b16 v[190:191], v19 offset:25600
  s_waitcnt lgkmcnt(12)
  v_mfma_f32_16x16x32_bf16 v[84:87], v[192:195], v[148:151], v[84:87]
  ds_read_b64_tr_b16 v[192:193], v20 offset:24576
  ds_read_b64_tr_b16 v[194:195], v20 offset:25600
  v_mfma_f32_16x16x32_bf16 v[88:91], v[196:199], v[148:151], v[88:91]
  ds_read_b64_tr_b16 v[196:197], v21 offset:24576
  ds_read_b64_tr_b16 v[198:199], v21 offset:25600
  s_waitcnt lgkmcnt(12)
  v_mfma_f32_16x16x32_bf16 v[60:63], v[168:171], v[152:155], v[60:63]
  v_mfma_f32_16x16x32_bf16 v[64:67], v[172:175], v[152:155], v[64:67]
  s_waitcnt lgkmcnt(8)
  v_mfma_f32_16x16x32_bf16 v[68:71], v[176:179], v[152:155], v[68:71]
  v_mfma_f32_16x16x32_bf16 v[72:75], v[180:183], v[152:155], v[72:75]
  s_waitcnt lgkmcnt(4)
  v_mfma_f32_16x16x32_bf16 v[76:79], v[184:187], v[152:155], v[76:79]
  v_mfma_f32_16x16x32_bf16 v[80:83], v[188:191], v[152:155], v[80:83]
  s_waitcnt lgkmcnt(0)
  v_mfma_f32_16x16x32_bf16 v[84:87], v[192:195], v[152:155], v[84:87]
  v_mfma_f32_16x16x32_bf16 v[88:91], v[196:199], v[152:155], v[88:91]
  s_nop 7
  buffer_store_dwordx4 v[60:63], v4, s[20:23], 0 offen offset:0 sc1
  buffer_store_dwordx4 v[64:67], v4, s[20:23], 0 offen offset:1024 sc1
  buffer_store_dwordx4 v[68:71], v4, s[20:23], 0 offen offset:2048 sc1
  buffer_store_dwordx4 v[72:75], v4, s[20:23], 0 offen offset:3072 sc1
  buffer_store_dwordx4 v[76:79], v5, s[20:23], 0 offen offset:0 sc1
  buffer_store_dwordx4 v[80:83], v5, s[20:23], 0 offen offset:1024 sc1
  buffer_store_dwordx4 v[84:87], v5, s[20:23], 0 offen offset:2048 sc1
  buffer_store_dwordx4 v[88:91], v5, s[20:23], 0 offen offset:3072 sc1
  s_waitcnt vmcnt(0)
  s_barrier
  s_barrier
  s_mov_b32 s3, 0
  buffer_load_dwordx4 v[124:127], v4, s[24:27], s3 offen sc1
  s_mov_b32 s3, 2359296
  buffer_load_dwordx4 v[128:131], v4, s[24:27], s3 offen sc1
  s_mov_b32 s3, 4718592
  buffer_load_dwordx4 v[132:135], v4, s[24:27], s3 offen sc1
  s_mov_b32 s3, 7077888
  buffer_load_dwordx4 v[136:139], v4, s[24:27], s3 offen sc1
  s_mov_b32 s3, 9437184
  buffer_load_dwordx4 v[140:143], v4, s[24:27], s3 offen sc1
  s_mov_b32 s3, 11796480
  buffer_load_dwordx4 v[144:147], v4, s[24:27], s3 offen sc1
  s_mov_b32 s3, 14155776
  buffer_load_dwordx4 v[148:151], v4, s[24:27], s3 offen sc1
  s_mov_b32 s3, 16515072
  buffer_load_dwordx4 v[152:155], v4, s[24:27], s3 offen sc1
  s_waitcnt vmcnt(6)
  v_add_f32 v124, v124, v128
  v_add_f32 v125, v125, v129
  v_add_f32 v126, v126, v130
  v_add_f32 v127, v127, v131
  s_waitcnt vmcnt(5)
  v_add_f32 v124, v124, v132
  v_add_f32 v125, v125, v133
  v_add_f32 v126, v126, v134
  v_add_f32 v127, v127, v135
  s_waitcnt vmcnt(4)
  v_add_f32 v124, v124, v136
  v_add_f32 v125, v125, v137
  v_add_f32 v126, v126, v138
  v_add_f32 v127, v127, v139
  s_waitcnt vmcnt(3)
  v_add_f32 v124, v124, v140
  v_add_f32 v125, v125, v141
  v_add_f32 v126, v126, v142
  v_add_f32 v127, v127, v143
  s_waitcnt vmcnt(2)
  v_add_f32 v124, v124, v144
  v_add_f32 v125, v125, v145
  v_add_f32 v126, v126, v146
  v_add_f32 v127, v127, v147
  s_waitcnt vmcnt(1)
  v_add_f32 v124, v124, v148
  v_add_f32 v125, v125, v149
  v_add_f32 v126, v126, v150
  v_add_f32 v127, v127, v151
  s_waitcnt vmcnt(0)
  v_add_f32 v124, v124, v152
  v_add_f32 v125, v125, v153
  v_add_f32 v126, v126, v154
  v_add_f32 v127, v127, v155
  v_cvt_pk_bf16_f32 v124, v124, v125
  v_cvt_pk_bf16_f32 v125, v126, v127
  buffer_store_dwordx2 v[124:125], v6, s[16:19], 0 offen
  s_endpgm
L_slowc1a:
  v_mov_b32 v25, v24
  s_nop 1
  v_permlane32_swap_b32 v24, v25
  v_max_f32 v24, v24, v25
  v_mov_b32 v25, v24
  s_nop 1
  v_permlane16_swap_b32 v24, v25
  v_max_f32 v24, v24, v25
  v_max_f32 v24, s61, v24
  v_sub_f32 v25, 0, v24
  v_min_f32 v25, 0, v25
  v_exp_f32 v25, v25
  s_mov_b32 s60, 0x41000000
  s_mov_b32 s61, 0
  v_sub_f32 v232, v232, v24
  v_sub_f32 v233, v233, v24
  v_sub_f32 v234, v234, v24
  v_sub_f32 v235, v235, v24
  v_sub_f32 v124, v124, v24
  v_sub_f32 v125, v125, v24
  v_sub_f32 v126, v126, v24
  v_sub_f32 v127, v127, v24
  v_sub_f32 v128, v128, v24
  v_sub_f32 v129, v129, v24
  v_sub_f32 v130, v130, v24
  v_sub_f32 v131, v131, v24
  v_mul_f32 v60, v60, v25
  v_mul_f32 v61, v61, v25
  v_mul_f32 v62, v62, v25
  v_mul_f32 v63, v63, v25
  v_mul_f32 v64, v64, v25
  v_mul_f32 v65, v65, v25
  v_mul_f32 v66, v66, v25
  v_mul_f32 v67, v67, v25
  v_mul_f32 v68, v68, v25
  v_mul_f32 v69, v69, v25
  v_mul_f32 v70, v70, v25
  v_mul_f32 v71, v71, v25
  v_mul_f32 v72, v72, v25
  v_mul_f32 v73, v73, v25
  v_mul_f32 v74, v74, v25
  v_mul_f32 v75, v75, v25
  v_mul_f32 v76, v76, v25
  v_mul_f32 v77, v77, v25
  v_mul_f32 v78, v78, v25
  v_mul_f32 v79, v79, v25
  v_mul_f32 v80, v80, v25
  v_mul_f32 v81, v81, v25
  v_mul_f32 v82, v82, v25
  v_mul_f32 v83, v83, v25
  v_mul_f32 v84, v84, v25
  v_mul_f32 v85, v85, v25
  v_mul_f32 v86, v86, v25
  v_mul_f32 v87, v87, v25
  v_mul_f32 v88, v88, v25
  v_mul_f32 v89, v89, v25
  v_mul_f32 v90, v90, v25
  v_mul_f32 v91, v91, v25
  v_mul_f32 v160, v160, v25
  v_mul_f32 v161, v161, v25
  v_mul_f32 v162, v162, v25
  v_mul_f32 v163, v163, v25
  s_branch L_backc1a
L_prod:
  s_lshl_b32 s39, s38, 8
  s_add_u32 s24, s10, s39
  s_addc_u32 s25, s11, 0
  s_sub_u32 s26, 4194304, s39
  s_mov_b32 s27, 0x00020000
  s_lshl_b32 s3, s37, 5
  s_add_u32 s3, s3, s38
  s_lshl_b32 s39, s3, 18
  s_lshr_b32 s40, s3, 14
  s_add_u32 s16, s6, s39
  s_addc_u32 s17, s7, s40
  s_add_u32 s20, s8, s39
  s_addc_u32 s21, s9, s40
  s_sub_u32 s45, s36, 6
  s_lshl_b32 s46, s45, 14
  s_cmp_eq_u32 s45, 0
  s_cselect_b32 s60, s16, s20
  s_cselect_b32 s61, s17, s21
  s_mov_b32 s62, 262144
  s_mov_b32 s63, 0x00020000
  v_add_u32 v24, 0, v2
  v_add_u32 v25, 0, v2
  v_lshlrev_b32 v25, 1, v25
  v_cndmask_b32 v24, v25, v24, s[48:49]
  v_xor_b32 v24, v24, v1
  v_lshlrev_b32 v24, 4, v24
  v_lshl_add_u32 v4, v2, 8, v24
  v_add_u32 v24, 4, v2
  v_add_u32 v25, 4, v2
  v_lshlrev_b32 v25, 1, v25
  v_cndmask_b32 v24, v25, v24, s[48:49]
  v_xor_b32 v24, v24, v1
  v_lshlrev_b32 v24, 4, v24
  v_lshl_add_u32 v5, v2, 8, v24
  v_add_u32 v24, 8, v2
  v_add_u32 v25, 0, v2
  v_lshlrev_b32 v25, 1, v25
  v_cndmask_b32 v24, v25, v24, s[48:49]
  v_xor_b32 v24, v24, v1
  v_lshlrev_b32 v24, 4, v24
  v_lshl_add_u32 v6, v2, 8, v24
  v_add_u32 v24, 12, v2
  v_add_u32 v25, 4, v2
  v_lshlrev_b32 v25, 1, v25
  v_cndmask_b32 v24, v25, v24, s[48:49]
  v_xor_b32 v24, v24, v1
  v_lshlrev_b32 v24, 4, v24
  v_lshl_add_u32 v7, v2, 8, v24
  v_add_u32 v24, 0, v2
  v_lshlrev_b32 v24, 1, v24
  v_xor_b32 v24, v24, v1
  v_lshlrev_b32 v24, 4, v24
  v_lshl_add_u32 v8, v2, 13, v24
  v_lshl_add_u32 v10, v2, 10, v24
  v_add_u32 v24, 4, v2
  v_lshlrev_b32 v24, 1, v24
  v_xor_b32 v24, v24, v1
  v_lshlrev_b32 v24, 4, v24
  v_lshl_add_u32 v9, v2, 13, v24
  v_lshl_add_u32 v11, v2, 10, v24
  s_lshl_b32 s47, s45, 19
  s_add_u32 s88, s12, 50331648
  s_addc_u32 s89, s13, 0
  s_mov_b32 s90, 65536
  s_mov_b32 s91, 0x00020000
  s_lshl_b32 s3, s2, 8
  v_mov_b32 v26, s3
  v_mov_b32 v27, 0
  s_cmp_lg_u32 s36, 6
  s_cbranch_scc1 L_noclr
  s_mov_b64 exec, 1
  buffer_store_dword v27, v26, s[88:91], 0 offen sc1
  buffer_store_dword v27, v26, s[88:91], 0 offen offset:128 sc1
  s_mov_b64 exec, -1
L_noclr:
  v_lshrrev_b32 v24, 3, v0
  v_and_b32 v25, 7, v0
  v_add_u32 v31, 0, v2
  v_xor_b32 v31, v31, v25
  v_lshlrev_b32 v31, 4, v31
  v_lshl_add_u32 v12, v24, 10, v31
  v_add_u32 v31, 4, v2
  v_xor_b32 v31, v31, v25
  v_lshlrev_b32 v31, 4, v31
  v_lshl_add_u32 v13, v24, 10, v31
  s_add_u32 s64, s46, 0
  s_cmp_eq_u32 s45, 0
  s_cbranch_scc0 L_ux1
  s_mov_b32 s65, 0
  s_mov_b32 m0, s64
  s_add_u32 s64, s64, 1024
  buffer_load_dwordx4 v8, s[24:27], s65 offen lds
  s_add_u32 s65, s65, 32768
  s_mov_b32 m0, s64
  s_add_u32 s64, s64, 1024
  buffer_load_dwordx4 v8, s[24:27], s65 offen lds
  s_add_u32 s65, s65, 32768
  s_mov_b32 m0, s64
  s_add_u32 s64, s64, 1024
  buffer_load_dwordx4 v9, s[24:27], s65 offen lds
  s_add_u32 s65, s65, 32768
  s_mov_b32 m0, s64
  s_add_u32 s64, s64, 1024
  buffer_load_dwordx4 v9, s[24:27], s65 offen lds
  s_add_u32 s65, s65, 32768
  s_mov_b32 m0, s64
  s_add_u32 s64, s64, 1024
  buffer_load_dwordx4 v8, s[24:27], s65 offen lds
  s_add_u32 s65, s65, 32768
  s_mov_b32 m0, s64
  s_add_u32 s64, s64, 1024
  buffer_load_dwordx4 v8, s[24:27], s65 offen lds
  s_add_u32 s65, s65, 32768
  s_mov_b32 m0, s64
  s_add_u32 s64, s64, 1024
  buffer_load_dwordx4 v9, s[24:27], s65 offen lds
  s_add_u32 s65, s65, 32768
  s_mov_b32 m0, s64
  s_add_u32 s64, s64, 1024
  buffer_load_dwordx4 v9, s[24:27], s65 offen lds
  s_add_u32 s65, s65, 32768
  s_mov_b32 m0, s64
  s_add_u32 s64, s64, 1024
  buffer_load_dwordx4 v8, s[24:27], s65 offen lds
  s_add_u32 s65, s65, 32768
  s_mov_b32 m0, s64
  s_add_u32 s64, s64, 1024
  buffer_load_dwordx4 v8, s[24:27], s65 offen lds
  s_add_u32 s65, s65, 32768
  s_mov_b32 m0, s64
  s_add_u32 s64, s64, 1024
  buffer_load_dwordx4 v9, s[24:27], s65 offen lds
  s_add_u32 s65, s65, 32768
  s_mov_b32 m0, s64
  s_add_u32 s64, s64, 1024
  buffer_load_dwordx4 v9, s[24:27], s65 offen lds
  s_add_u32 s65, s65, 32768
  s_mov_b32 m0, s64
  s_add_u32 s64, s64, 1024
  buffer_load_dwordx4 v8, s[24:27], s65 offen lds
  s_add_u32 s65, s65, 32768
  s_mov_b32 m0, s64
  s_add_u32 s64, s64, 1024
  buffer_load_dwordx4 v8, s[24:27], s65 offen lds
  s_add_u32 s65, s65, 32768
  s_mov_b32 m0, s64
  s_add_u32 s64, s64, 1024
  buffer_load_dwordx4 v9, s[24:27], s65 offen lds
  s_add_u32 s65, s65, 32768
  s_mov_b32 m0, s64
  s_add_u32 s64, s64, 1024
  buffer_load_dwordx4 v9, s[24:27], s65 offen lds
  s_branch L_uj1
L_ux1:
  s_mov_b32 s65, 0
  s_mov_b32 m0, s64
  s_add_u32 s64, s64, 1024
  buffer_load_dwordx4 v12, s[28:31], s65 offen lds
  s_add_u32 s65, s65, 8192
  s_mov_b32 m0, s64
  s_add_u32 s64, s64, 1024
  buffer_load_dwordx4 v13, s[28:31], s65 offen lds
  s_add_u32 s65, s65, 8192
  s_mov_b32 m0, s64
  s_add_u32 s64, s64, 1024
  buffer_load_dwordx4 v12, s[28:31], s65 offen lds
  s_add_u32 s65, s65, 8192
  s_mov_b32 m0, s64
  s_add_u32 s64, s64, 1024
  buffer_load_dwordx4 v13, s[28:31], s65 offen lds
  s_add_u32 s65, s65, 8192
  s_mov_b32 m0, s64
  s_add_u32 s64, s64, 1024
  buffer_load_dwordx4 v12, s[28:31], s65 offen lds
  s_add_u32 s65, s65, 8192
  s_mov_b32 m0, s64
  s_add_u32 s64, s64, 1024
  buffer_load_dwordx4 v13, s[28:31], s65 offen lds
  s_add_u32 s65, s65, 8192
  s_mov_b32 m0, s64
  s_add_u32 s64, s64, 1024
  buffer_load_dwordx4 v12, s[28:31], s65 offen lds
  s_add_u32 s65, s65, 8192
  s_mov_b32 m0, s64
  s_add_u32 s64, s64, 1024
  buffer_load_dwordx4 v13, s[28:31], s65 offen lds
  s_add_u32 s65, s65, 8192
  s_mov_b32 m0, s64
  s_add_u32 s64, s64, 1024
  buffer_load_dwordx4 v12, s[28:31], s65 offen lds
  s_add_u32 s65, s65, 8192
  s_mov_b32 m0, s64
  s_add_u32 s64, s64, 1024
  buffer_load_dwordx4 v13, s[28:31], s65 offen lds
  s_add_u32 s65, s65, 8192
  s_mov_b32 m0, s64
  s_add_u32 s64, s64, 1024
  buffer_load_dwordx4 v12, s[28:31], s65 offen lds
  s_add_u32 s65, s65, 8192
  s_mov_b32 m0, s64
  s_add_u32 s64, s64, 1024
  buffer_load_dwordx4 v13, s[28:31], s65 offen lds
  s_add_u32 s65, s65, 8192
  s_mov_b32 m0, s64
  s_add_u32 s64, s64, 1024
  buffer_load_dwordx4 v12, s[28:31], s65 offen lds
  s_add_u32 s65, s65, 8192
  s_mov_b32 m0, s64
  s_add_u32 s64, s64, 1024
  buffer_load_dwordx4 v13, s[28:31], s65 offen lds
  s_add_u32 s65, s65, 8192
  s_mov_b32 m0, s64
  s_add_u32 s64, s64, 1024
  buffer_load_dwordx4 v12, s[28:31], s65 offen lds
  s_add_u32 s65, s65, 8192
  s_mov_b32 m0, s64
  s_add_u32 s64, s64, 1024
  buffer_load_dwordx4 v13, s[28:31], s65 offen lds
L_uj1:
  s_add_u32 s64, s46, 32768
  s_cmp_eq_u32 s45, 0
  s_cbranch_scc0 L_ux2
  s_mov_b32 s65, 524288
  s_mov_b32 m0, s64
  s_add_u32 s64, s64, 1024
  buffer_load_dwordx4 v8, s[24:27], s65 offen lds
  s_add_u32 s65, s65, 32768
  s_mov_b32 m0, s64
  s_add_u32 s64, s64, 1024
  buffer_load_dwordx4 v8, s[24:27], s65 offen lds
  s_add_u32 s65, s65, 32768
  s_mov_b32 m0, s64
  s_add_u32 s64, s64, 1024
  buffer_load_dwordx4 v9, s[24:27], s65 offen lds
  s_add_u32 s65, s65, 32768
  s_mov_b32 m0, s64
  s_add_u32 s64, s64, 1024
  buffer_load_dwordx4 v9, s[24:27], s65 offen lds
  s_add_u32 s65, s65, 32768
  s_mov_b32 m0, s64
  s_add_u32 s64, s64, 1024
  buffer_load_dwordx4 v8, s[24:27], s65 offen lds
  s_add_u32 s65, s65, 32768
  s_mov_b32 m0, s64
  s_add_u32 s64, s64, 1024
  buffer_load_dwordx4 v8, s[24:27], s65 offen lds
  s_add_u32 s65, s65, 32768
  s_mov_b32 m0, s64
  s_add_u32 s64, s64, 1024
  buffer_load_dwordx4 v9, s[24:27], s65 offen lds
  s_add_u32 s65, s65, 32768
  s_mov_b32 m0, s64
  s_add_u32 s64, s64, 1024
  buffer_load_dwordx4 v9, s[24:27], s65 offen lds
  s_add_u32 s65, s65, 32768
  s_mov_b32 m0, s64
  s_add_u32 s64, s64, 1024
  buffer_load_dwordx4 v8, s[24:27], s65 offen lds
  s_add_u32 s65, s65, 32768
  s_mov_b32 m0, s64
  s_add_u32 s64, s64, 1024
  buffer_load_dwordx4 v8, s[24:27], s65 offen lds
  s_add_u32 s65, s65, 32768
  s_mov_b32 m0, s64
  s_add_u32 s64, s64, 1024
  buffer_load_dwordx4 v9, s[24:27], s65 offen lds
  s_add_u32 s65, s65, 32768
  s_mov_b32 m0, s64
  s_add_u32 s64, s64, 1024
  buffer_load_dwordx4 v9, s[24:27], s65 offen lds
  s_add_u32 s65, s65, 32768
  s_mov_b32 m0, s64
  s_add_u32 s64, s64, 1024
  buffer_load_dwordx4 v8, s[24:27], s65 offen lds
  s_add_u32 s65, s65, 32768
  s_mov_b32 m0, s64
  s_add_u32 s64, s64, 1024
  buffer_load_dwordx4 v8, s[24:27], s65 offen lds
  s_add_u32 s65, s65, 32768
  s_mov_b32 m0, s64
  s_add_u32 s64, s64, 1024
  buffer_load_dwordx4 v9, s[24:27], s65 offen lds
  s_add_u32 s65, s65, 32768
  s_mov_b32 m0, s64
  s_add_u32 s64, s64, 1024
  buffer_load_dwordx4 v9, s[24:27], s65 offen lds
  s_branch L_uj2
L_ux2:
  s_mov_b32 s65, 128
  s_mov_b32 m0, s64
  s_add_u32 s64, s64, 1024
  buffer_load_dwordx4 v12, s[28:31], s65 offen lds
  s_add_u32 s65, s65, 8192
  s_mov_b32 m0, s64
  s_add_u32 s64, s64, 1024
  buffer_load_dwordx4 v13, s[28:31], s65 offen lds
  s_add_u32 s65, s65, 8192
  s_mov_b32 m0, s64
  s_add_u32 s64, s64, 1024
  buffer_load_dwordx4 v12, s[28:31], s65 offen lds
  s_add_u32 s65, s65, 8192
  s_mov_b32 m0, s64
  s_add_u32 s64, s64, 1024
  buffer_load_dwordx4 v13, s[28:31], s65 offen lds
  s_add_u32 s65, s65, 8192
  s_mov_b32 m0, s64
  s_add_u32 s64, s64, 1024
  buffer_load_dwordx4 v12, s[28:31], s65 offen lds
  s_add_u32 s65, s65, 8192
  s_mov_b32 m0, s64
  s_add_u32 s64, s64, 1024
  buffer_load_dwordx4 v13, s[28:31], s65 offen lds
  s_add_u32 s65, s65, 8192
  s_mov_b32 m0, s64
  s_add_u32 s64, s64, 1024
  buffer_load_dwordx4 v12, s[28:31], s65 offen lds
  s_add_u32 s65, s65, 8192
  s_mov_b32 m0, s64
  s_add_u32 s64, s64, 1024
  buffer_load_dwordx4 v13, s[28:31], s65 offen lds
  s_add_u32 s65, s65, 8192
  s_mov_b32 m0, s64
  s_add_u32 s64, s64, 1024
  buffer_load_dwordx4 v12, s[28:31], s65 offen lds
  s_add_u32 s65, s65, 8192
  s_mov_b32 m0, s64
  s_add_u32 s64, s64, 1024
  buffer_load_dwordx4 v13, s[28:31], s65 offen lds
  s_add_u32 s65, s65, 8192
  s_mov_b32 m0, s64
  s_add_u32 s64, s64, 1024
  buffer_load_dwordx4 v12, s[28:31], s65 offen lds
  s_add_u32 s65, s65, 8192
  s_mov_b32 m0, s64
  s_add_u32 s64, s64, 1024
  buffer_load_dwordx4 v13, s[28:31], s65 offen lds
  s_add_u32 s65, s65, 8192
  s_mov_b32 m0, s64
  s_add_u32 s64, s64, 1024
  buffer_load_dwordx4 v12, s[28:31], s65 offen lds
  s_add_u32 s65, s65, 8192
  s_mov_b32 m0, s64
  s_add_u32 s64, s64, 1024
  buffer_load_dwordx4 v13, s[28:31], s65 offen lds
  s_add_u32 s65, s65, 8192
  s_mov_b32 m0, s64
  s_add_u32 s64, s64, 1024
  buffer_load_dwordx4 v12, s[28:31], s65 offen lds
  s_add_u32 s65, s65, 8192
  s_mov_b32 m0, s64
  s_add_u32 s64, s64, 1024
  buffer_load_dwordx4 v13, s[28:31], s65 offen lds
L_uj2:
  s_add_u32 s64, s46, 65536
  s_cmp_eq_u32 s45, 0
  s_cbranch_scc0 L_ux3
  s_mov_b32 s65, 1048576
  s_mov_b32 m0, s64
  s_add_u32 s64, s64, 1024
  buffer_load_dwordx4 v8, s[24:27], s65 offen lds
  s_add_u32 s65, s65, 32768
  s_mov_b32 m0, s64
  s_add_u32 s64, s64, 1024
  buffer_load_dwordx4 v8, s[24:27], s65 offen lds
  s_add_u32 s65, s65, 32768
  s_mov_b32 m0, s64
  s_add_u32 s64, s64, 1024
  buffer_load_dwordx4 v9, s[24:27], s65 offen lds
  s_add_u32 s65, s65, 32768
  s_mov_b32 m0, s64
  s_add_u32 s64, s64, 1024
  buffer_load_dwordx4 v9, s[24:27], s65 offen lds
  s_add_u32 s65, s65, 32768
  s_mov_b32 m0, s64
  s_add_u32 s64, s64, 1024
  buffer_load_dwordx4 v8, s[24:27], s65 offen lds
  s_add_u32 s65, s65, 32768
  s_mov_b32 m0, s64
  s_add_u32 s64, s64, 1024
  buffer_load_dwordx4 v8, s[24:27], s65 offen lds
  s_add_u32 s65, s65, 32768
  s_mov_b32 m0, s64
  s_add_u32 s64, s64, 1024
  buffer_load_dwordx4 v9, s[24:27], s65 offen lds
  s_add_u32 s65, s65, 32768
  s_mov_b32 m0, s64
  s_add_u32 s64, s64, 1024
  buffer_load_dwordx4 v9, s[24:27], s65 offen lds
  s_add_u32 s65, s65, 32768
  s_mov_b32 m0, s64
  s_add_u32 s64, s64, 1024
  buffer_load_dwordx4 v8, s[24:27], s65 offen lds
  s_add_u32 s65, s65, 32768
  s_mov_b32 m0, s64
  s_add_u32 s64, s64, 1024
  buffer_load_dwordx4 v8, s[24:27], s65 offen lds
  s_add_u32 s65, s65, 32768
  s_mov_b32 m0, s64
  s_add_u32 s64, s64, 1024
  buffer_load_dwordx4 v9, s[24:27], s65 offen lds
  s_add_u32 s65, s65, 32768
  s_mov_b32 m0, s64
  s_add_u32 s64, s64, 1024
  buffer_load_dwordx4 v9, s[24:27], s65 offen lds
  s_add_u32 s65, s65, 32768
  s_mov_b32 m0, s64
  s_add_u32 s64, s64, 1024
  buffer_load_dwordx4 v8, s[24:27], s65 offen lds
  s_add_u32 s65, s65, 32768
  s_mov_b32 m0, s64
  s_add_u32 s64, s64, 1024
  buffer_load_dwordx4 v8, s[24:27], s65 offen lds
  s_add_u32 s65, s65, 32768
  s_mov_b32 m0, s64
  s_add_u32 s64, s64, 1024
  buffer_load_dwordx4 v9, s[24:27], s65 offen lds
  s_add_u32 s65, s65, 32768
  s_mov_b32 m0, s64
  s_add_u32 s64, s64, 1024
  buffer_load_dwordx4 v9, s[24:27], s65 offen lds
  s_branch L_uj3
L_ux3:
  s_mov_b32 s65, 256
  s_mov_b32 m0, s64
  s_add_u32 s64, s64, 1024
  buffer_load_dwordx4 v12, s[28:31], s65 offen lds
  s_add_u32 s65, s65, 8192
  s_mov_b32 m0, s64
  s_add_u32 s64, s64, 1024
  buffer_load_dwordx4 v13, s[28:31], s65 offen lds
  s_add_u32 s65, s65, 8192
  s_mov_b32 m0, s64
  s_add_u32 s64, s64, 1024
  buffer_load_dwordx4 v12, s[28:31], s65 offen lds
  s_add_u32 s65, s65, 8192
  s_mov_b32 m0, s64
  s_add_u32 s64, s64, 1024
  buffer_load_dwordx4 v13, s[28:31], s65 offen lds
  s_add_u32 s65, s65, 8192
  s_mov_b32 m0, s64
  s_add_u32 s64, s64, 1024
  buffer_load_dwordx4 v12, s[28:31], s65 offen lds
  s_add_u32 s65, s65, 8192
  s_mov_b32 m0, s64
  s_add_u32 s64, s64, 1024
  buffer_load_dwordx4 v13, s[28:31], s65 offen lds
  s_add_u32 s65, s65, 8192
  s_mov_b32 m0, s64
  s_add_u32 s64, s64, 1024
  buffer_load_dwordx4 v12, s[28:31], s65 offen lds
  s_add_u32 s65, s65, 8192
  s_mov_b32 m0, s64
  s_add_u32 s64, s64, 1024
  buffer_load_dwordx4 v13, s[28:31], s65 offen lds
  s_add_u32 s65, s65, 8192
  s_mov_b32 m0, s64
  s_add_u32 s64, s64, 1024
  buffer_load_dwordx4 v12, s[28:31], s65 offen lds
  s_add_u32 s65, s65, 8192
  s_mov_b32 m0, s64
  s_add_u32 s64, s64, 1024
  buffer_load_dwordx4 v13, s[28:31], s65 offen lds
  s_add_u32 s65, s65, 8192
  s_mov_b32 m0, s64
  s_add_u32 s64, s64, 1024
  buffer_load_dwordx4 v12, s[28:31], s65 offen lds
  s_add_u32 s65, s65, 8192
  s_mov_b32 m0, s64
  s_add_u32 s64, s64, 1024
  buffer_load_dwordx4 v13, s[28:31], s65 offen lds
  s_add_u32 s65, s65, 8192
  s_mov_b32 m0, s64
  s_add_u32 s64, s64, 1024
  buffer_load_dwordx4 v12, s[28:31], s65 offen lds
  s_add_u32 s65, s65, 8192
  s_mov_b32 m0, s64
  s_add_u32 s64, s64, 1024
  buffer_load_dwordx4 v13, s[28:31], s65 offen lds
  s_add_u32 s65, s65, 8192
  s_mov_b32 m0, s64
  s_add_u32 s64, s64, 1024
  buffer_load_dwordx4 v12, s[28:31], s65 offen lds
  s_add_u32 s65, s65, 8192
  s_mov_b32 m0, s64
  s_add_u32 s64, s64, 1024
  buffer_load_dwordx4 v13, s[28:31], s65 offen lds
L_uj3:
  s_waitcnt vmcnt(32)
  s_barrier
  s_add_u32 s64, s46, 98304
  s_cmp_eq_u32 s45, 0
  s_cbranch_scc0 L_ux4
  s_mov_b32 s65, 1572864
  s_mov_b32 m0, s64
  s_add_u32 s64, s64, 1024
  buffer_load_dwordx4 v8, s[24:27], s65 offen lds
  s_add_u32 s65, s65, 32768
  s_mov_b32 m0, s64
  s_add_u32 s64, s64, 1024
  buffer_load_dwordx4 v8, s[24:27], s65 offen lds
  s_add_u32 s65, s65, 32768
  s_mov_b32 m0, s64
  s_add_u32 s64, s64, 1024
  buffer_load_dwordx4 v9, s[24:27], s65 offen lds
  s_add_u32 s65, s65, 32768
  s_mov_b32 m0, s64
  s_add_u32 s64, s64, 1024
  buffer_load_dwordx4 v9, s[24:27], s65 offen lds
  s_add_u32 s65, s65, 32768
  s_mov_b32 m0, s64
  s_add_u32 s64, s64, 1024
  buffer_load_dwordx4 v8, s[24:27], s65 offen lds
  s_add_u32 s65, s65, 32768
  s_mov_b32 m0, s64
  s_add_u32 s64, s64, 1024
  buffer_load_dwordx4 v8, s[24:27], s65 offen lds
  s_add_u32 s65, s65, 32768
  s_mov_b32 m0, s64
  s_add_u32 s64, s64, 1024
  buffer_load_dwordx4 v9, s[24:27], s65 offen lds
  s_add_u32 s65, s65, 32768
  s_mov_b32 m0, s64
  s_add_u32 s64, s64, 1024
  buffer_load_dwordx4 v9, s[24:27], s65 offen lds
  s_add_u32 s65, s65, 32768
  s_mov_b32 m0, s64
  s_add_u32 s64, s64, 1024
  buffer_load_dwordx4 v8, s[24:27], s65 offen lds
  s_add_u32 s65, s65, 32768
  s_mov_b32 m0, s64
  s_add_u32 s64, s64, 1024
  buffer_load_dwordx4 v8, s[24:27], s65 offen lds
  s_add_u32 s65, s65, 32768
  s_mov_b32 m0, s64
  s_add_u32 s64, s64, 1024
  buffer_load_dwordx4 v9, s[24:27], s65 offen lds
  s_add_u32 s65, s65, 32768
  s_mov_b32 m0, s64
  s_add_u32 s64, s64, 1024
  buffer_load_dwordx4 v9, s[24:27], s65 offen lds
  s_add_u32 s65, s65, 32768
  s_mov_b32 m0, s64
  s_add_u32 s64, s64, 1024
  buffer_load_dwordx4 v8, s[24:27], s65 offen lds
  s_add_u32 s65, s65, 32768
  s_mov_b32 m0, s64
  s_add_u32 s64, s64, 1024
  buffer_load_dwordx4 v8, s[24:27], s65 offen lds
  s_add_u32 s65, s65, 32768
  s_mov_b32 m0, s64
  s_add_u32 s64, s64, 1024
  buffer_load_dwordx4 v9, s[24:27], s65 offen lds
  s_add_u32 s65, s65, 32768
  s_mov_b32 m0, s64
  s_add_u32 s64, s64, 1024
  buffer_load_dwordx4 v9, s[24:27], s65 offen lds
  s_branch L_uj4
L_ux4:
  s_mov_b32 s65, 384
  s_mov_b32 m0, s64
  s_add_u32 s64, s64, 1024
  buffer_load_dwordx4 v12, s[28:31], s65 offen lds
  s_add_u32 s65, s65, 8192
  s_mov_b32 m0, s64
  s_add_u32 s64, s64, 1024
  buffer_load_dwordx4 v13, s[28:31], s65 offen lds
  s_add_u32 s65, s65, 8192
  s_mov_b32 m0, s64
  s_add_u32 s64, s64, 1024
  buffer_load_dwordx4 v12, s[28:31], s65 offen lds
  s_add_u32 s65, s65, 8192
  s_mov_b32 m0, s64
  s_add_u32 s64, s64, 1024
  buffer_load_dwordx4 v13, s[28:31], s65 offen lds
  s_add_u32 s65, s65, 8192
  s_mov_b32 m0, s64
  s_add_u32 s64, s64, 1024
  buffer_load_dwordx4 v12, s[28:31], s65 offen lds
  s_add_u32 s65, s65, 8192
  s_mov_b32 m0, s64
  s_add_u32 s64, s64, 1024
  buffer_load_dwordx4 v13, s[28:31], s65 offen lds
  s_add_u32 s65, s65, 8192
  s_mov_b32 m0, s64
  s_add_u32 s64, s64, 1024
  buffer_load_dwordx4 v12, s[28:31], s65 offen lds
  s_add_u32 s65, s65, 8192
  s_mov_b32 m0, s64
  s_add_u32 s64, s64, 1024
  buffer_load_dwordx4 v13, s[28:31], s65 offen lds
  s_add_u32 s65, s65, 8192
  s_mov_b32 m0, s64
  s_add_u32 s64, s64, 1024
  buffer_load_dwordx4 v12, s[28:31], s65 offen lds
  s_add_u32 s65, s65, 8192
  s_mov_b32 m0, s64
  s_add_u32 s64, s64, 1024
  buffer_load_dwordx4 v13, s[28:31], s65 offen lds
  s_add_u32 s65, s65, 8192
  s_mov_b32 m0, s64
  s_add_u32 s64, s64, 1024
  buffer_load_dwordx4 v12, s[28:31], s65 offen lds
  s_add_u32 s65, s65, 8192
  s_mov_b32 m0, s64
  s_add_u32 s64, s64, 1024
  buffer_load_dwordx4 v13, s[28:31], s65 offen lds
  s_add_u32 s65, s65, 8192
  s_mov_b32 m0, s64
  s_add_u32 s64, s64, 1024
  buffer_load_dwordx4 v12, s[28:31], s65 offen lds
  s_add_u32 s65, s65, 8192
  s_mov_b32 m0, s64
  s_add_u32 s64, s64, 1024
  buffer_load_dwordx4 v13, s[28:31], s65 offen lds
  s_add_u32 s65, s65, 8192
  s_mov_b32 m0, s64
  s_add_u32 s64, s64, 1024
  buffer_load_dwordx4 v12, s[28:31], s65 offen lds
  s_add_u32 s65, s65, 8192
  s_mov_b32 m0, s64
  s_add_u32 s64, s64, 1024
  buffer_load_dwordx4 v13, s[28:31], s65 offen lds
L_uj4:
  s_add_u32 s64, s46, 131072
  s_mov_b32 s65, 0
  s_mov_b32 m0, s64
  s_add_u32 s64, s64, 4096
  buffer_load_dwordx4 v4, s[60:63], s65 offen offset:0 nt lds
  buffer_load_dwordx4 v5, s[60:63], s65 offen offset:1024 nt lds
  buffer_load_dwordx4 v6, s[60:63], s65 offen offset:2048 nt lds
  buffer_load_dwordx4 v7, s[60:63], s65 offen offset:3072 nt lds
  s_add_u32 s65, s65, 4096
  s_mov_b32 m0, s64
  s_add_u32 s64, s64, 4096
  buffer_load_dwordx4 v4, s[60:63], s65 offen offset:0 nt lds
  buffer_load_dwordx4 v5, s[60:63], s65 offen offset:1024 nt lds
  buffer_load_dwordx4 v6, s[60:63], s65 offen offset:2048 nt lds
  buffer_load_dwordx4 v7, s[60:63], s65 offen offset:3072 nt lds
  s_add_u32 s65, s65, 4096
  s_mov_b32 m0, s64
  s_add_u32 s64, s64, 4096
  buffer_load_dwordx4 v4, s[60:63], s65 offen offset:0 nt lds
  buffer_load_dwordx4 v5, s[60:63], s65 offen offset:1024 nt lds
  buffer_load_dwordx4 v6, s[60:63], s65 offen offset:2048 nt lds
  buffer_load_dwordx4 v7, s[60:63], s65 offen offset:3072 nt lds
  s_add_u32 s65, s65, 4096
  s_mov_b32 m0, s64
  s_add_u32 s64, s64, 4096
  buffer_load_dwordx4 v4, s[60:63], s65 offen offset:0 nt lds
  buffer_load_dwordx4 v5, s[60:63], s65 offen offset:1024 nt lds
  buffer_load_dwordx4 v6, s[60:63], s65 offen offset:2048 nt lds
  buffer_load_dwordx4 v7, s[60:63], s65 offen offset:3072 nt lds
  s_waitcnt vmcnt(48)
  s_barrier
  s_add_u32 s64, s46, 0
  s_cmp_eq_u32 s45, 0
  s_cbranch_scc0 L_ux5
  s_mov_b32 s65, 2097152
  s_mov_b32 m0, s64
  s_add_u32 s64, s64, 1024
  buffer_load_dwordx4 v8, s[24:27], s65 offen lds
  s_add_u32 s65, s65, 32768
  s_mov_b32 m0, s64
  s_add_u32 s64, s64, 1024
  buffer_load_dwordx4 v8, s[24:27], s65 offen lds
  s_add_u32 s65, s65, 32768
  s_mov_b32 m0, s64
  s_add_u32 s64, s64, 1024
  buffer_load_dwordx4 v9, s[24:27], s65 offen lds
  s_add_u32 s65, s65, 32768
  s_mov_b32 m0, s64
  s_add_u32 s64, s64, 1024
  buffer_load_dwordx4 v9, s[24:27], s65 offen lds
  s_add_u32 s65, s65, 32768
  s_mov_b32 m0, s64
  s_add_u32 s64, s64, 1024
  buffer_load_dwordx4 v8, s[24:27], s65 offen lds
  s_add_u32 s65, s65, 32768
  s_mov_b32 m0, s64
  s_add_u32 s64, s64, 1024
  buffer_load_dwordx4 v8, s[24:27], s65 offen lds
  s_add_u32 s65, s65, 32768
  s_mov_b32 m0, s64
  s_add_u32 s64, s64, 1024
  buffer_load_dwordx4 v9, s[24:27], s65 offen lds
  s_add_u32 s65, s65, 32768
  s_mov_b32 m0, s64
  s_add_u32 s64, s64, 1024
  buffer_load_dwordx4 v9, s[24:27], s65 offen lds
  s_add_u32 s65, s65, 32768
  s_mov_b32 m0, s64
  s_add_u32 s64, s64, 1024
  buffer_load_dwordx4 v8, s[24:27], s65 offen lds
  s_add_u32 s65, s65, 32768
  s_mov_b32 m0, s64
  s_add_u32 s64, s64, 1024
  buffer_load_dwordx4 v8, s[24:27], s65 offen lds
  s_add_u32 s65, s65, 32768
  s_mov_b32 m0, s64
  s_add_u32 s64, s64, 1024
  buffer_load_dwordx4 v9, s[24:27], s65 offen lds
  s_add_u32 s65, s65, 32768
  s_mov_b32 m0, s64
  s_add_u32 s64, s64, 1024
  buffer_load_dwordx4 v9, s[24:27], s65 offen lds
  s_add_u32 s65, s65, 32768
  s_mov_b32 m0, s64
  s_add_u32 s64, s64, 1024
  buffer_load_dwordx4 v8, s[24:27], s65 offen lds
  s_add_u32 s65, s65, 32768
  s_mov_b32 m0, s64
  s_add_u32 s64, s64, 1024
  buffer_load_dwordx4 v8, s[24:27], s65 offen lds
  s_add_u32 s65, s65, 32768
  s_mov_b32 m0, s64
  s_add_u32 s64, s64, 1024
  buffer_load_dwordx4 v9, s[24:27], s65 offen lds
  s_add_u32 s65, s65, 32768
  s_mov_b32 m0, s64
  s_add_u32 s64, s64, 1024
  buffer_load_dwordx4 v9, s[24:27], s65 offen lds
  s_branch L_uj5
L_ux5:
  s_mov_b32 s65, 512
  s_mov_b32 m0, s64
  s_add_u32 s64, s64, 1024
  buffer_load_dwordx4 v12, s[28:31], s65 offen lds
  s_add_u32 s65, s65, 8192
  s_mov_b32 m0, s64
  s_add_u32 s64, s64, 1024
  buffer_load_dwordx4 v13, s[28:31], s65 offen lds
  s_add_u32 s65, s65, 8192
  s_mov_b32 m0, s64
  s_add_u32 s64, s64, 1024
  buffer_load_dwordx4 v12, s[28:31], s65 offen lds
  s_add_u32 s65, s65, 8192
  s_mov_b32 m0, s64
  s_add_u32 s64, s64, 1024
  buffer_load_dwordx4 v13, s[28:31], s65 offen lds
  s_add_u32 s65, s65, 8192
  s_mov_b32 m0, s64
  s_add_u32 s64, s64, 1024
  buffer_load_dwordx4 v12, s[28:31], s65 offen lds
  s_add_u32 s65, s65, 8192
  s_mov_b32 m0, s64
  s_add_u32 s64, s64, 1024
  buffer_load_dwordx4 v13, s[28:31], s65 offen lds
  s_add_u32 s65, s65, 8192
  s_mov_b32 m0, s64
  s_add_u32 s64, s64, 1024
  buffer_load_dwordx4 v12, s[28:31], s65 offen lds
  s_add_u32 s65, s65, 8192
  s_mov_b32 m0, s64
  s_add_u32 s64, s64, 1024
  buffer_load_dwordx4 v13, s[28:31], s65 offen lds
  s_add_u32 s65, s65, 8192
  s_mov_b32 m0, s64
  s_add_u32 s64, s64, 1024
  buffer_load_dwordx4 v12, s[28:31], s65 offen lds
  s_add_u32 s65, s65, 8192
  s_mov_b32 m0, s64
  s_add_u32 s64, s64, 1024
  buffer_load_dwordx4 v13, s[28:31], s65 offen lds
  s_add_u32 s65, s65, 8192
  s_mov_b32 m0, s64
  s_add_u32 s64, s64, 1024
  buffer_load_dwordx4 v12, s[28:31], s65 offen lds
  s_add_u32 s65, s65, 8192
  s_mov_b32 m0, s64
  s_add_u32 s64, s64, 1024
  buffer_load_dwordx4 v13, s[28:31], s65 offen lds
  s_add_u32 s65, s65, 8192
  s_mov_b32 m0, s64
  s_add_u32 s64, s64, 1024
  buffer_load_dwordx4 v12, s[28:31], s65 offen lds
  s_add_u32 s65, s65, 8192
  s_mov_b32 m0, s64
  s_add_u32 s64, s64, 1024
  buffer_load_dwordx4 v13, s[28:31], s65 offen lds
  s_add_u32 s65, s65, 8192
  s_mov_b32 m0, s64
  s_add_u32 s64, s64, 1024
  buffer_load_dwordx4 v12, s[28:31], s65 offen lds
  s_add_u32 s65, s65, 8192
  s_mov_b32 m0, s64
  s_add_u32 s64, s64, 1024
  buffer_load_dwordx4 v13, s[28:31], s65 offen lds
L_uj5:
  s_waitcnt vmcnt(48)
  s_barrier
  s_add_u32 s64, s46, 32768
  s_cmp_eq_u32 s45, 0
  s_cbranch_scc0 L_ux6
  s_mov_b32 s65, 2621440
  s_mov_b32 m0, s64
  s_add_u32 s64, s64, 1024
  buffer_load_dwordx4 v8, s[24:27], s65 offen lds
  s_add_u32 s65, s65, 32768
  s_mov_b32 m0, s64
  s_add_u32 s64, s64, 1024
  buffer_load_dwordx4 v8, s[24:27], s65 offen lds
  s_add_u32 s65, s65, 32768
  s_mov_b32 m0, s64
  s_add_u32 s64, s64, 1024
  buffer_load_dwordx4 v9, s[24:27], s65 offen lds
  s_add_u32 s65, s65, 32768
  s_mov_b32 m0, s64
  s_add_u32 s64, s64, 1024
  buffer_load_dwordx4 v9, s[24:27], s65 offen lds
  s_add_u32 s65, s65, 32768
  s_mov_b32 m0, s64
  s_add_u32 s64, s64, 1024
  buffer_load_dwordx4 v8, s[24:27], s65 offen lds
  s_add_u32 s65, s65, 32768
  s_mov_b32 m0, s64
  s_add_u32 s64, s64, 1024
  buffer_load_dwordx4 v8, s[24:27], s65 offen lds
  s_add_u32 s65, s65, 32768
  s_mov_b32 m0, s64
  s_add_u32 s64, s64, 1024
  buffer_load_dwordx4 v9, s[24:27], s65 offen lds
  s_add_u32 s65, s65, 32768
  s_mov_b32 m0, s64
  s_add_u32 s64, s64, 1024
  buffer_load_dwordx4 v9, s[24:27], s65 offen lds
  s_add_u32 s65, s65, 32768
  s_mov_b32 m0, s64
  s_add_u32 s64, s64, 1024
  buffer_load_dwordx4 v8, s[24:27], s65 offen lds
  s_add_u32 s65, s65, 32768
  s_mov_b32 m0, s64
  s_add_u32 s64, s64, 1024
  buffer_load_dwordx4 v8, s[24:27], s65 offen lds
  s_add_u32 s65, s65, 32768
  s_mov_b32 m0, s64
  s_add_u32 s64, s64, 1024
  buffer_load_dwordx4 v9, s[24:27], s65 offen lds
  s_add_u32 s65, s65, 32768
  s_mov_b32 m0, s64
  s_add_u32 s64, s64, 1024
  buffer_load_dwordx4 v9, s[24:27], s65 offen lds
  s_add_u32 s65, s65, 32768
  s_mov_b32 m0, s64
  s_add_u32 s64, s64, 1024
  buffer_load_dwordx4 v8, s[24:27], s65 offen lds
  s_add_u32 s65, s65, 32768
  s_mov_b32 m0, s64
  s_add_u32 s64, s64, 1024
  buffer_load_dwordx4 v8, s[24:27], s65 offen lds
  s_add_u32 s65, s65, 32768
  s_mov_b32 m0, s64
  s_add_u32 s64, s64, 1024
  buffer_load_dwordx4 v9, s[24:27], s65 offen lds
  s_add_u32 s65, s65, 32768
  s_mov_b32 m0, s64
  s_add_u32 s64, s64, 1024
  buffer_load_dwordx4 v9, s[24:27], s65 offen lds
  s_branch L_uj6
L_ux6:
  s_mov_b32 s65, 640
  s_mov_b32 m0, s64
  s_add_u32 s64, s64, 1024
  buffer_load_dwordx4 v12, s[28:31], s65 offen lds
  s_add_u32 s65, s65, 8192
  s_mov_b32 m0, s64
  s_add_u32 s64, s64, 1024
  buffer_load_dwordx4 v13, s[28:31], s65 offen lds
  s_add_u32 s65, s65, 8192
  s_mov_b32 m0, s64
  s_add_u32 s64, s64, 1024
  buffer_load_dwordx4 v12, s[28:31], s65 offen lds
  s_add_u32 s65, s65, 8192
  s_mov_b32 m0, s64
  s_add_u32 s64, s64, 1024
  buffer_load_dwordx4 v13, s[28:31], s65 offen lds
  s_add_u32 s65, s65, 8192
  s_mov_b32 m0, s64
  s_add_u32 s64, s64, 1024
  buffer_load_dwordx4 v12, s[28:31], s65 offen lds
  s_add_u32 s65, s65, 8192
  s_mov_b32 m0, s64
  s_add_u32 s64, s64, 1024
  buffer_load_dwordx4 v13, s[28:31], s65 offen lds
  s_add_u32 s65, s65, 8192
  s_mov_b32 m0, s64
  s_add_u32 s64, s64, 1024
  buffer_load_dwordx4 v12, s[28:31], s65 offen lds
  s_add_u32 s65, s65, 8192
  s_mov_b32 m0, s64
  s_add_u32 s64, s64, 1024
  buffer_load_dwordx4 v13, s[28:31], s65 offen lds
  s_add_u32 s65, s65, 8192
  s_mov_b32 m0, s64
  s_add_u32 s64, s64, 1024
  buffer_load_dwordx4 v12, s[28:31], s65 offen lds
  s_add_u32 s65, s65, 8192
  s_mov_b32 m0, s64
  s_add_u32 s64, s64, 1024
  buffer_load_dwordx4 v13, s[28:31], s65 offen lds
  s_add_u32 s65, s65, 8192
  s_mov_b32 m0, s64
  s_add_u32 s64, s64, 1024
  buffer_load_dwordx4 v12, s[28:31], s65 offen lds
  s_add_u32 s65, s65, 8192
  s_mov_b32 m0, s64
  s_add_u32 s64, s64, 1024
  buffer_load_dwordx4 v13, s[28:31], s65 offen lds
  s_add_u32 s65, s65, 8192
  s_mov_b32 m0, s64
  s_add_u32 s64, s64, 1024
  buffer_load_dwordx4 v12, s[28:31], s65 offen lds
  s_add_u32 s65, s65, 8192
  s_mov_b32 m0, s64
  s_add_u32 s64, s64, 1024
  buffer_load_dwordx4 v13, s[28:31], s65 offen lds
  s_add_u32 s65, s65, 8192
  s_mov_b32 m0, s64
  s_add_u32 s64, s64, 1024
  buffer_load_dwordx4 v12, s[28:31], s65 offen lds
  s_add_u32 s65, s65, 8192
  s_mov_b32 m0, s64
  s_add_u32 s64, s64, 1024
  buffer_load_dwordx4 v13, s[28:31], s65 offen lds
L_uj6:
  s_waitcnt vmcnt(48)
  s_barrier
  s_add_u32 s64, s46, 65536
  s_cmp_eq_u32 s45, 0
  s_cbranch_scc0 L_ux7
  s_mov_b32 s65, 3145728
  s_mov_b32 m0, s64
  s_add_u32 s64, s64, 1024
  buffer_load_dwordx4 v8, s[24:27], s65 offen lds
  s_add_u32 s65, s65, 32768
  s_mov_b32 m0, s64
  s_add_u32 s64, s64, 1024
  buffer_load_dwordx4 v8, s[24:27], s65 offen lds
  s_add_u32 s65, s65, 32768
  s_mov_b32 m0, s64
  s_add_u32 s64, s64, 1024
  buffer_load_dwordx4 v9, s[24:27], s65 offen lds
  s_add_u32 s65, s65, 32768
  s_mov_b32 m0, s64
  s_add_u32 s64, s64, 1024
  buffer_load_dwordx4 v9, s[24:27], s65 offen lds
  s_add_u32 s65, s65, 32768
  s_mov_b32 m0, s64
  s_add_u32 s64, s64, 1024
  buffer_load_dwordx4 v8, s[24:27], s65 offen lds
  s_add_u32 s65, s65, 32768
  s_mov_b32 m0, s64
  s_add_u32 s64, s64, 1024
  buffer_load_dwordx4 v8, s[24:27], s65 offen lds
  s_add_u32 s65, s65, 32768
  s_mov_b32 m0, s64
  s_add_u32 s64, s64, 1024
  buffer_load_dwordx4 v9, s[24:27], s65 offen lds
  s_add_u32 s65, s65, 32768
  s_mov_b32 m0, s64
  s_add_u32 s64, s64, 1024
  buffer_load_dwordx4 v9, s[24:27], s65 offen lds
  s_add_u32 s65, s65, 32768
  s_mov_b32 m0, s64
  s_add_u32 s64, s64, 1024
  buffer_load_dwordx4 v8, s[24:27], s65 offen lds
  s_add_u32 s65, s65, 32768
  s_mov_b32 m0, s64
  s_add_u32 s64, s64, 1024
  buffer_load_dwordx4 v8, s[24:27], s65 offen lds
  s_add_u32 s65, s65, 32768
  s_mov_b32 m0, s64
  s_add_u32 s64, s64, 1024
  buffer_load_dwordx4 v9, s[24:27], s65 offen lds
  s_add_u32 s65, s65, 32768
  s_mov_b32 m0, s64
  s_add_u32 s64, s64, 1024
  buffer_load_dwordx4 v9, s[24:27], s65 offen lds
  s_add_u32 s65, s65, 32768
  s_mov_b32 m0, s64
  s_add_u32 s64, s64, 1024
  buffer_load_dwordx4 v8, s[24:27], s65 offen lds
  s_add_u32 s65, s65, 32768
  s_mov_b32 m0, s64
  s_add_u32 s64, s64, 1024
  buffer_load_dwordx4 v8, s[24:27], s65 offen lds
  s_add_u32 s65, s65, 32768
  s_mov_b32 m0, s64
  s_add_u32 s64, s64, 1024
  buffer_load_dwordx4 v9, s[24:27], s65 offen lds
  s_add_u32 s65, s65, 32768
  s_mov_b32 m0, s64
  s_add_u32 s64, s64, 1024
  buffer_load_dwordx4 v9, s[24:27], s65 offen lds
  s_branch L_uj7
L_ux7:
  s_mov_b32 s65, 768
  s_mov_b32 m0, s64
  s_add_u32 s64, s64, 1024
  buffer_load_dwordx4 v12, s[28:31], s65 offen lds
  s_add_u32 s65, s65, 8192
  s_mov_b32 m0, s64
  s_add_u32 s64, s64, 1024
  buffer_load_dwordx4 v13, s[28:31], s65 offen lds
  s_add_u32 s65, s65, 8192
  s_mov_b32 m0, s64
  s_add_u32 s64, s64, 1024
  buffer_load_dwordx4 v12, s[28:31], s65 offen lds
  s_add_u32 s65, s65, 8192
  s_mov_b32 m0, s64
  s_add_u32 s64, s64, 1024
  buffer_load_dwordx4 v13, s[28:31], s65 offen lds
  s_add_u32 s65, s65, 8192
  s_mov_b32 m0, s64
  s_add_u32 s64, s64, 1024
  buffer_load_dwordx4 v12, s[28:31], s65 offen lds
  s_add_u32 s65, s65, 8192
  s_mov_b32 m0, s64
  s_add_u32 s64, s64, 1024
  buffer_load_dwordx4 v13, s[28:31], s65 offen lds
  s_add_u32 s65, s65, 8192
  s_mov_b32 m0, s64
  s_add_u32 s64, s64, 1024
  buffer_load_dwordx4 v12, s[28:31], s65 offen lds
  s_add_u32 s65, s65, 8192
  s_mov_b32 m0, s64
  s_add_u32 s64, s64, 1024
  buffer_load_dwordx4 v13, s[28:31], s65 offen lds
  s_add_u32 s65, s65, 8192
  s_mov_b32 m0, s64
  s_add_u32 s64, s64, 1024
  buffer_load_dwordx4 v12, s[28:31], s65 offen lds
  s_add_u32 s65, s65, 8192
  s_mov_b32 m0, s64
  s_add_u32 s64, s64, 1024
  buffer_load_dwordx4 v13, s[28:31], s65 offen lds
  s_add_u32 s65, s65, 8192
  s_mov_b32 m0, s64
  s_add_u32 s64, s64, 1024
  buffer_load_dwordx4 v12, s[28:31], s65 offen lds
  s_add_u32 s65, s65, 8192
  s_mov_b32 m0, s64
  s_add_u32 s64, s64, 1024
  buffer_load_dwordx4 v13, s[28:31], s65 offen lds
  s_add_u32 s65, s65, 8192
  s_mov_b32 m0, s64
  s_add_u32 s64, s64, 1024
  buffer_load_dwordx4 v12, s[28:31], s65 offen lds
  s_add_u32 s65, s65, 8192
  s_mov_b32 m0, s64
  s_add_u32 s64, s64, 1024
  buffer_load_dwordx4 v13, s[28:31], s65 offen lds
  s_add_u32 s65, s65, 8192
  s_mov_b32 m0, s64
  s_add_u32 s64, s64, 1024
  buffer_load_dwordx4 v12, s[28:31], s65 offen lds
  s_add_u32 s65, s65, 8192
  s_mov_b32 m0, s64
  s_add_u32 s64, s64, 1024
  buffer_load_dwordx4 v13, s[28:31], s65 offen lds
L_uj7:
  s_waitcnt vmcnt(32)
  s_barrier
  s_add_u32 s64, s46, 98304
  s_cmp_eq_u32 s45, 0
  s_cbranch_scc0 L_ux8
  s_mov_b32 s65, 3670016
  s_mov_b32 m0, s64
  s_add_u32 s64, s64, 1024
  buffer_load_dwordx4 v8, s[24:27], s65 offen lds
  s_add_u32 s65, s65, 32768
  s_mov_b32 m0, s64
  s_add_u32 s64, s64, 1024
  buffer_load_dwordx4 v8, s[24:27], s65 offen lds
  s_add_u32 s65, s65, 32768
  s_mov_b32 m0, s64
  s_add_u32 s64, s64, 1024
  buffer_load_dwordx4 v9, s[24:27], s65 offen lds
  s_add_u32 s65, s65, 32768
  s_mov_b32 m0, s64
  s_add_u32 s64, s64, 1024
  buffer_load_dwordx4 v9, s[24:27], s65 offen lds
  s_add_u32 s65, s65, 32768
  s_mov_b32 m0, s64
  s_add_u32 s64, s64, 1024
  buffer_load_dwordx4 v8, s[24:27], s65 offen lds
  s_add_u32 s65, s65, 32768
  s_mov_b32 m0, s64
  s_add_u32 s64, s64, 1024
  buffer_load_dwordx4 v8, s[24:27], s65 offen lds
  s_add_u32 s65, s65, 32768
  s_mov_b32 m0, s64
  s_add_u32 s64, s64, 1024
  buffer_load_dwordx4 v9, s[24:27], s65 offen lds
  s_add_u32 s65, s65, 32768
  s_mov_b32 m0, s64
  s_add_u32 s64, s64, 1024
  buffer_load_dwordx4 v9, s[24:27], s65 offen lds
  s_add_u32 s65, s65, 32768
  s_mov_b32 m0, s64
  s_add_u32 s64, s64, 1024
  buffer_load_dwordx4 v8, s[24:27], s65 offen lds
  s_add_u32 s65, s65, 32768
  s_mov_b32 m0, s64
  s_add_u32 s64, s64, 1024
  buffer_load_dwordx4 v8, s[24:27], s65 offen lds
  s_add_u32 s65, s65, 32768
  s_mov_b32 m0, s64
  s_add_u32 s64, s64, 1024
  buffer_load_dwordx4 v9, s[24:27], s65 offen lds
  s_add_u32 s65, s65, 32768
  s_mov_b32 m0, s64
  s_add_u32 s64, s64, 1024
  buffer_load_dwordx4 v9, s[24:27], s65 offen lds
  s_add_u32 s65, s65, 32768
  s_mov_b32 m0, s64
  s_add_u32 s64, s64, 1024
  buffer_load_dwordx4 v8, s[24:27], s65 offen lds
  s_add_u32 s65, s65, 32768
  s_mov_b32 m0, s64
  s_add_u32 s64, s64, 1024
  buffer_load_dwordx4 v8, s[24:27], s65 offen lds
  s_add_u32 s65, s65, 32768
  s_mov_b32 m0, s64
  s_add_u32 s64, s64, 1024
  buffer_load_dwordx4 v9, s[24:27], s65 offen lds
  s_add_u32 s65, s65, 32768
  s_mov_b32 m0, s64
  s_add_u32 s64, s64, 1024
  buffer_load_dwordx4 v9, s[24:27], s65 offen lds
  s_branch L_uj8
L_ux8:
  s_mov_b32 s65, 896
  s_mov_b32 m0, s64
  s_add_u32 s64, s64, 1024
  buffer_load_dwordx4 v12, s[28:31], s65 offen lds
  s_add_u32 s65, s65, 8192
  s_mov_b32 m0, s64
  s_add_u32 s64, s64, 1024
  buffer_load_dwordx4 v13, s[28:31], s65 offen lds
  s_add_u32 s65, s65, 8192
  s_mov_b32 m0, s64
  s_add_u32 s64, s64, 1024
  buffer_load_dwordx4 v12, s[28:31], s65 offen lds
  s_add_u32 s65, s65, 8192
  s_mov_b32 m0, s64
  s_add_u32 s64, s64, 1024
  buffer_load_dwordx4 v13, s[28:31], s65 offen lds
  s_add_u32 s65, s65, 8192
  s_mov_b32 m0, s64
  s_add_u32 s64, s64, 1024
  buffer_load_dwordx4 v12, s[28:31], s65 offen lds
  s_add_u32 s65, s65, 8192
  s_mov_b32 m0, s64
  s_add_u32 s64, s64, 1024
  buffer_load_dwordx4 v13, s[28:31], s65 offen lds
  s_add_u32 s65, s65, 8192
  s_mov_b32 m0, s64
  s_add_u32 s64, s64, 1024
  buffer_load_dwordx4 v12, s[28:31], s65 offen lds
  s_add_u32 s65, s65, 8192
  s_mov_b32 m0, s64
  s_add_u32 s64, s64, 1024
  buffer_load_dwordx4 v13, s[28:31], s65 offen lds
  s_add_u32 s65, s65, 8192
  s_mov_b32 m0, s64
  s_add_u32 s64, s64, 1024
  buffer_load_dwordx4 v12, s[28:31], s65 offen lds
  s_add_u32 s65, s65, 8192
  s_mov_b32 m0, s64
  s_add_u32 s64, s64, 1024
  buffer_load_dwordx4 v13, s[28:31], s65 offen lds
  s_add_u32 s65, s65, 8192
  s_mov_b32 m0, s64
  s_add_u32 s64, s64, 1024
  buffer_load_dwordx4 v12, s[28:31], s65 offen lds
  s_add_u32 s65, s65, 8192
  s_mov_b32 m0, s64
  s_add_u32 s64, s64, 1024
  buffer_load_dwordx4 v13, s[28:31], s65 offen lds
  s_add_u32 s65, s65, 8192
  s_mov_b32 m0, s64
  s_add_u32 s64, s64, 1024
  buffer_load_dwordx4 v12, s[28:31], s65 offen lds
  s_add_u32 s65, s65, 8192
  s_mov_b32 m0, s64
  s_add_u32 s64, s64, 1024
  buffer_load_dwordx4 v13, s[28:31], s65 offen lds
  s_add_u32 s65, s65, 8192
  s_mov_b32 m0, s64
  s_add_u32 s64, s64, 1024
  buffer_load_dwordx4 v12, s[28:31], s65 offen lds
  s_add_u32 s65, s65, 8192
  s_mov_b32 m0, s64
  s_add_u32 s64, s64, 1024
  buffer_load_dwordx4 v13, s[28:31], s65 offen lds
L_uj8:
  s_waitcnt vmcnt(32)
  s_barrier
  s_add_u32 s64, s46, 0
  s_mov_b32 s65, 16384
  s_mov_b32 m0, s64
  s_add_u32 s64, s64, 4096
  buffer_load_dwordx4 v4, s[60:63], s65 offen offset:0 nt lds
  buffer_load_dwordx4 v5, s[60:63], s65 offen offset:1024 nt lds
  buffer_load_dwordx4 v6, s[60:63], s65 offen offset:2048 nt lds
  buffer_load_dwordx4 v7, s[60:63], s65 offen offset:3072 nt lds
  s_add_u32 s65, s65, 4096
  s_mov_b32 m0, s64
  s_add_u32 s64, s64, 4096
  buffer_load_dwordx4 v4, s[60:63], s65 offen offset:0 nt lds
  buffer_load_dwordx4 v5, s[60:63], s65 offen offset:1024 nt lds
  buffer_load_dwordx4 v6, s[60:63], s65 offen offset:2048 nt lds
  buffer_load_dwordx4 v7, s[60:63], s65 offen offset:3072 nt lds
  s_add_u32 s65, s65, 4096
  s_mov_b32 m0, s64
  s_add_u32 s64, s64, 4096
  buffer_load_dwordx4 v4, s[60:63], s65 offen offset:0 nt lds
  buffer_load_dwordx4 v5, s[60:63], s65 offen offset:1024 nt lds
  buffer_load_dwordx4 v6, s[60:63], s65 offen offset:2048 nt lds
  buffer_load_dwordx4 v7, s[60:63], s65 offen offset:3072 nt lds
  s_add_u32 s65, s65, 4096
  s_mov_b32 m0, s64
  s_add_u32 s64, s64, 4096
  buffer_load_dwordx4 v4, s[60:63], s65 offen offset:0 nt lds
  buffer_load_dwordx4 v5, s[60:63], s65 offen offset:1024 nt lds
  buffer_load_dwordx4 v6, s[60:63], s65 offen offset:2048 nt lds
  buffer_load_dwordx4 v7, s[60:63], s65 offen offset:3072 nt lds
  s_waitcnt vmcnt(32)
  s_barrier
  s_add_u32 s64, s46, 32768
  s_mov_b32 s65, 32768
  s_mov_b32 m0, s64
  s_add_u32 s64, s64, 4096
  buffer_load_dwordx4 v4, s[60:63], s65 offen offset:0 nt lds
  buffer_load_dwordx4 v5, s[60:63], s65 offen offset:1024 nt lds
  buffer_load_dwordx4 v6, s[60:63], s65 offen offset:2048 nt lds
  buffer_load_dwordx4 v7, s[60:63], s65 offen offset:3072 nt lds
  s_add_u32 s65, s65, 4096
  s_mov_b32 m0, s64
  s_add_u32 s64, s64, 4096
  buffer_load_dwordx4 v4, s[60:63], s65 offen offset:0 nt lds
  buffer_load_dwordx4 v5, s[60:63], s65 offen offset:1024 nt lds
  buffer_load_dwordx4 v6, s[60:63], s65 offen offset:2048 nt lds
  buffer_load_dwordx4 v7, s[60:63], s65 offen offset:3072 nt lds
  s_add_u32 s65, s65, 4096
  s_mov_b32 m0, s64
  s_add_u32 s64, s64, 4096
  buffer_load_dwordx4 v4, s[60:63], s65 offen offset:0 nt lds
  buffer_load_dwordx4 v5, s[60:63], s65 offen offset:1024 nt lds
  buffer_load_dwordx4 v6, s[60:63], s65 offen offset:2048 nt lds
  buffer_load_dwordx4 v7, s[60:63], s65 offen offset:3072 nt lds
  s_add_u32 s65, s65, 4096
  s_mov_b32 m0, s64
  s_add_u32 s64, s64, 4096
  buffer_load_dwordx4 v4, s[60:63], s65 offen offset:0 nt lds
  buffer_load_dwordx4 v5, s[60:63], s65 offen offset:1024 nt lds
  buffer_load_dwordx4 v6, s[60:63], s65 offen offset:2048 nt lds
  buffer_load_dwordx4 v7, s[60:63], s65 offen offset:3072 nt lds
  s_waitcnt vmcnt(32)
  s_barrier
  s_add_u32 s64, s46, 65536
  s_mov_b32 s65, 49152
  s_mov_b32 m0, s64
  s_add_u32 s64, s64, 4096
  buffer_load_dwordx4 v4, s[60:63], s65 offen offset:0 nt lds
  buffer_load_dwordx4 v5, s[60:63], s65 offen offset:1024 nt lds
  buffer_load_dwordx4 v6, s[60:63], s65 offen offset:2048 nt lds
  buffer_load_dwordx4 v7, s[60:63], s65 offen offset:3072 nt lds
  s_add_u32 s65, s65, 4096
  s_mov_b32 m0, s64
  s_add_u32 s64, s64, 4096
  buffer_load_dwordx4 v4, s[60:63], s65 offen offset:0 nt lds
  buffer_load_dwordx4 v5, s[60:63], s65 offen offset:1024 nt lds
  buffer_load_dwordx4 v6, s[60:63], s65 offen offset:2048 nt lds
  buffer_load_dwordx4 v7, s[60:63], s65 offen offset:3072 nt lds
  s_add_u32 s65, s65, 4096
  s_mov_b32 m0, s64
  s_add_u32 s64, s64, 4096
  buffer_load_dwordx4 v4, s[60:63], s65 offen offset:0 nt lds
  buffer_load_dwordx4 v5, s[60:63], s65 offen offset:1024 nt lds
  buffer_load_dwordx4 v6, s[60:63], s65 offen offset:2048 nt lds
  buffer_load_dwordx4 v7, s[60:63], s65 offen offset:3072 nt lds
  s_add_u32 s65, s65, 4096
  s_mov_b32 m0, s64
  s_add_u32 s64, s64, 4096
  buffer_load_dwordx4 v4, s[60:63], s65 offen offset:0 nt lds
  buffer_load_dwordx4 v5, s[60:63], s65 offen offset:1024 nt lds
  buffer_load_dwordx4 v6, s[60:63], s65 offen offset:2048 nt lds
  buffer_load_dwordx4 v7, s[60:63], s65 offen offset:3072 nt lds
  s_barrier
  s_add_u32 s64, s46, 98304
  s_mov_b32 s65, 65536
  s_mov_b32 m0, s64
  s_add_u32 s64, s64, 4096
  buffer_load_dwordx4 v4, s[60:63], s65 offen offset:0 nt lds
  buffer_load_dwordx4 v5, s[60:63], s65 offen offset:1024 nt lds
  buffer_load_dwordx4 v6, s[60:63], s65 offen offset:2048 nt lds
  buffer_load_dwordx4 v7, s[60:63], s65 offen offset:3072 nt lds
  s_add_u32 s65, s65, 4096
  s_mov_b32 m0, s64
  s_add_u32 s64, s64, 4096
  buffer_load_dwordx4 v4, s[60:63], s65 offen offset:0 nt lds
  buffer_load_dwordx4 v5, s[60:63], s65 offen offset:1024 nt lds
  buffer_load_dwordx4 v6, s[60:63], s65 offen offset:2048 nt lds
  buffer_load_dwordx4 v7, s[60:63], s65 offen offset:3072 nt lds
  s_add_u32 s65, s65, 4096
  s_mov_b32 m0, s64
  s_add_u32 s64, s64, 4096
  buffer_load_dwordx4 v4, s[60:63], s65 offen offset:0 nt lds
  buffer_load_dwordx4 v5, s[60:63], s65 offen offset:1024 nt lds
  buffer_load_dwordx4 v6, s[60:63], s65 offen offset:2048 nt lds
  buffer_load_dwordx4 v7, s[60:63], s65 offen offset:3072 nt lds
  s_add_u32 s65, s65, 4096
  s_mov_b32 m0, s64
  s_add_u32 s64, s64, 4096
  buffer_load_dwordx4 v4, s[60:63], s65 offen offset:0 nt lds
  buffer_load_dwordx4 v5, s[60:63], s65 offen offset:1024 nt lds
  buffer_load_dwordx4 v6, s[60:63], s65 offen offset:2048 nt lds
  buffer_load_dwordx4 v7, s[60:63], s65 offen offset:3072 nt lds
  s_mov_b32 s40, 0
  s_mov_b32 s41, 131072
  s_mov_b32 s43, 81920
  s_lshr_b32 s66, s38, 2
  s_and_b32 s67, s38, 3
  s_lshl_b32 s3, s66, 19
  s_lshl_b32 s64, s67, 8
  s_add_u32 s3, s3, s64
  s_add_u32 s80, s72, s3
  s_addc_u32 s81, s73, 0
  s_sub_u32 s82, 4194304, s3
  s_mov_b32 s83, 0x00020000
L_loopP:
  s_waitcnt vmcnt(48)
  s_barrier
  s_add_u32 s64, s46, s41
  s_mov_b32 s65, s43
  s_mov_b32 m0, s64
  s_add_u32 s64, s64, 4096
  buffer_load_dwordx4 v4, s[60:63], s65 offen offset:0 nt lds
  buffer_load_dwordx4 v5, s[60:63], s65 offen offset:1024 nt lds
  buffer_load_dwordx4 v6, s[60:63], s65 offen offset:2048 nt lds
  buffer_load_dwordx4 v7, s[60:63], s65 offen offset:3072 nt lds
  s_add_u32 s65, s65, 4096
  s_mov_b32 m0, s64
  s_add_u32 s64, s64, 4096
  buffer_load_dwordx4 v4, s[60:63], s65 offen offset:0 nt lds
  buffer_load_dwordx4 v5, s[60:63], s65 offen offset:1024 nt lds
  buffer_load_dwordx4 v6, s[60:63], s65 offen offset:2048 nt lds
  buffer_load_dwordx4 v7, s[60:63], s65 offen offset:3072 nt lds
  s_add_u32 s65, s65, 4096
  s_mov_b32 m0, s64
  s_add_u32 s64, s64, 4096
  buffer_load_dwordx4 v4, s[60:63], s65 offen offset:0 nt lds
  buffer_load_dwordx4 v5, s[60:63], s65 offen offset:1024 nt lds
  buffer_load_dwordx4 v6, s[60:63], s65 offen offset:2048 nt lds
  buffer_load_dwordx4 v7, s[60:63], s65 offen offset:3072 nt lds
  s_add_u32 s65, s65, 4096
  s_mov_b32 m0, s64
  s_add_u32 s64, s64, 4096
  buffer_load_dwordx4 v4, s[60:63], s65 offen offset:0 nt lds
  buffer_load_dwordx4 v5, s[60:63], s65 offen offset:1024 nt lds
  buffer_load_dwordx4 v6, s[60:63], s65 offen offset:2048 nt lds
  buffer_load_dwordx4 v7, s[60:63], s65 offen offset:3072 nt lds
  s_add_u32 s41, s41, 32768
  s_cmp_ge_u32 s41, 163840
  s_cselect_b32 s41, 0, s41
  s_add_u32 s43, s43, 16384
  s_add_u32 s40, s40, 1
  s_cmp_lt_u32 s40, 11
  s_cbranch_scc1 L_loopP
  s_lshl_b32 s43, s45, 16
  s_mov_b32 s40, 0
L_loopW:
  s_waitcnt vmcnt(48)
  s_barrier
  s_add_u32 s64, s46, s41
  s_mov_b32 s65, s43
  s_mov_b32 m0, s64
  s_add_u32 s64, s64, 1024
  buffer_load_dwordx4 v10, s[80:83], s65 offen lds
  s_add_u32 s65, s65, 4096
  s_mov_b32 m0, s64
  s_add_u32 s64, s64, 1024
  buffer_load_dwordx4 v10, s[80:83], s65 offen lds
  s_add_u32 s65, s65, 4096
  s_mov_b32 m0, s64
  s_add_u32 s64, s64, 1024
  buffer_load_dwordx4 v10, s[80:83], s65 offen lds
  s_add_u32 s65, s65, 4096
  s_mov_b32 m0, s64
  s_add_u32 s64, s64, 1024
  buffer_load_dwordx4 v10, s[80:83], s65 offen lds
  s_add_u32 s65, s65, 4096
  s_mov_b32 m0, s64
  s_add_u32 s64, s64, 1024
  buffer_load_dwordx4 v11, s[80:83], s65 offen lds
  s_add_u32 s65, s65, 4096
  s_mov_b32 m0, s64
  s_add_u32 s64, s64, 1024
  buffer_load_dwordx4 v11, s[80:83], s65 offen lds
  s_add_u32 s65, s65, 4096
  s_mov_b32 m0, s64
  s_add_u32 s64, s64, 1024
  buffer_load_dwordx4 v11, s[80:83], s65 offen lds
  s_add_u32 s65, s65, 4096
  s_mov_b32 m0, s64
  s_add_u32 s64, s64, 1024
  buffer_load_dwordx4 v11, s[80:83], s65 offen lds
  s_add_u32 s65, s65, 4096
  s_mov_b32 m0, s64
  s_add_u32 s64, s64, 1024
  buffer_load_dwordx4 v10, s[80:83], s65 offen lds
  s_add_u32 s65, s65, 4096
  s_mov_b32 m0, s64
  s_add_u32 s64, s64, 1024
  buffer_load_dwordx4 v10, s[80:83], s65 offen lds
  s_add_u32 s65, s65, 4096
  s_mov_b32 m0, s64
  s_add_u32 s64, s64, 1024
  buffer_load_dwordx4 v10, s[80:83], s65 offen lds
  s_add_u32 s65, s65, 4096
  s_mov_b32 m0, s64
  s_add_u32 s64, s64, 1024
  buffer_load_dwordx4 v10, s[80:83], s65 offen lds
  s_add_u32 s65, s65, 4096
  s_mov_b32 m0, s64
  s_add_u32 s64, s64, 1024
  buffer_load_dwordx4 v11, s[80:83], s65 offen lds
  s_add_u32 s65, s65, 4096
  s_mov_b32 m0, s64
  s_add_u32 s64, s64, 1024
  buffer_load_dwordx4 v11, s[80:83], s65 offen lds
  s_add_u32 s65, s65, 4096
  s_mov_b32 m0, s64
  s_add_u32 s64, s64, 1024
  buffer_load_dwordx4 v11, s[80:83], s65 offen lds
  s_add_u32 s65, s65, 4096
  s_mov_b32 m0, s64
  s_add_u32 s64, s64, 1024
  buffer_load_dwordx4 v11, s[80:83], s65 offen lds
  s_add_u32 s41, s41, 32768
  s_add_u32 s43, s43, 131072
  s_add_u32 s40, s40, 1
  s_cmp_lt_u32 s40, 4
  s_cbranch_scc1 L_loopW
  s_barrier
  s_mov_b32 s84, s76
  s_mov_b32 s85, s77
  s_mov_b32 s86, 256
  s_mov_b32 s87, 0x00020000
  s_lshl_b32 s3, s37, 3
  s_add_u32 s3, s3, s66
  s_lshl_b32 s3, s3, 2
  v_mov_b32 v21, s3
  s_lshl_b32 s3, s37, 2
  s_add_u32 s3, s3, s67
  s_lshl_b32 s3, s3, 2
  v_mov_b32 v23, s3
  v_mov_b32 v20, 1
  v_mov_b32 v22, 0x10000
  s_barrier
  s_waitcnt vmcnt(0)
  s_barrier
  s_lshl_b32 s3, s37, 5
  s_add_u32 s3, s3, s66
  v_lshl_add_u32 v28, v0, 3, s3
  v_lshlrev_b32 v28, 8, v28
  s_lshl_b32 s3, s37, 2
  s_add_u32 s3, s3, s67
  s_lshl_b32 s3, s3, 3
  v_add_u32 v29, s3, v0
  v_lshlrev_b32 v29, 8, v29
  v_mov_b32 v30, 1
  s_cmp_lg_u32 s36, 6
  s_cbranch_scc1 L_sd1
  s_mov_b64 exec, 1
  buffer_atomic_add v20, v21, s[84:87], 0 offen sc0 sc1
  s_waitcnt vmcnt(0)
  v_readfirstlane_b32 s3, v20
  s_and_b32 s3, s3, 3
  s_cmp_lg_u32 s3, 3
  s_cbranch_scc1 L_sw1
  s_mov_b64 exec, 15
  buffer_store_dword v30, v28, s[88:91], 0 offen offset:0 sc1
  s_branch L_sx1
L_sw1:
  s_mov_b32 s40, 0
L_sp1:
  buffer_load_dword v24, v26, s[88:91], 0 offen offset:0 sc1
  s_waitcnt vmcnt(0)
  v_readfirstlane_b32 s3, v24
  s_cmp_eq_u32 s3, 1
  s_cbranch_scc1 L_sx1
  s_sleep 1
  s_add_u32 s40, s40, 1
  s_cmp_lt_u32 s40, 0x10000
  s_cbranch_scc1 L_sp1
L_sx1:
  s_mov_b64 exec, -1
L_sd1:
  s_barrier
  s_barrier
  s_cmp_lg_u32 s36, 6
  s_cbranch_scc1 L_sd2
  s_mov_b64 exec, 1
  buffer_atomic_add v22, v23, s[84:87], 0 offen sc0 sc1
  s_waitcnt vmcnt(0)
  v_readfirstlane_b32 s3, v22
  s_lshr_b32 s3, s3, 16
  s_and_b32 s3, s3, 7
  s_cmp_lg_u32 s3, 7
  s_cbranch_scc1 L_sw2
  s_mov_b64 exec, 255
  buffer_store_dword v30, v29, s[88:91], 0 offen offset:128 sc1
  s_branch L_sx2
L_sw2:
  s_mov_b32 s40, 0
L_sp2:
  buffer_load_dword v24, v26, s[88:91], 0 offen offset:128 sc1
  s_waitcnt vmcnt(0)
  v_readfirstlane_b32 s3, v24
  s_cmp_eq_u32 s3, 1
  s_cbranch_scc1 L_sx2
  s_sleep 1
  s_add_u32 s40, s40, 1
  s_cmp_lt_u32 s40, 0x10000
  s_cbranch_scc1 L_sp2
L_sx2:
  s_mov_b64 exec, -1
L_sd2:
  s_barrier
  s_endpgm
L_attn_done:
  s_endpgm
.section .rodata,"a"
.p2align 6
.amdhsa_kernel standalone__gqa_block_cached__near_ridge_kernel
  .amdhsa_next_free_vgpr 256
  .amdhsa_next_free_sgpr 96
  .amdhsa_accum_offset 256
  .amdhsa_group_segment_fixed_size 0
  .amdhsa_kernarg_size 64
  .amdhsa_user_sgpr_count 2
  .amdhsa_user_sgpr_kernarg_segment_ptr 1
  .amdhsa_system_sgpr_workgroup_id_x 1
.end_amdhsa_kernel
```
